```python
import torch

def _softmax(x, axis=-1):
    return torch.softmax(x, dim=axis)

def _gelu(x):
    return torch.nn.functional.gelu(x, approximate='tanh')

def _silu(x):
    return torch.nn.functional.silu(x)

def _sigmoid(x):
    return torch.sigmoid(x)

def _layernorm(x, axis=-1, eps=1e-05):
    m = x.mean(dim=axis, keepdim=True)
    v = x.var(dim=axis, keepdim=True, unbiased=False)
    return (x - m) / torch.sqrt(v + eps)

def _scatter_add(tgt, idx, src, axis=0):
    return tgt.clone().index_add_(axis, idx, src)

def _segment_sum(src, seg, n):
    out = torch.zeros((n,) + src.shape[1:], dtype=src.dtype)
    return out.index_add_(0, seg, src)

def _pad(x, pw):
    flat = tuple((v for pair in reversed(pw) for v in pair))
    return torch.nn.functional.pad(x, flat)
kernel_name = 'adaLN_cond__gqa_block_cached__geglu_ffn__decode'

def setup_inputs():

    _w = lambda a: (lambda t: t.to(torch.bfloat16) if t.is_floating_point() else t)(torch.as_tensor(a))

    def _A_setup():
        B, Sq, D = (1, 1, 512)
        Hq, Hkv, Sk, Dh = (32, 8, 16384, 128)
        assert Hq % Hkv == 0, (Hq, Hkv)
        return {'x': _w((lambda *s: torch.randn(*s, dtype=torch.bfloat16) * 0.1)(B, Sq, D)), 'k_cache': _w((lambda *s: torch.randn(*s, dtype=torch.bfloat16) * 0.8)(B, Hkv, Sk, Dh)), 'v_cache': _w((lambda *s: torch.randn(*s, dtype=torch.bfloat16) * 0.8)(B, Hkv, Sk, Dh)), 'wq': _w((lambda *s: torch.randn(*s, dtype=torch.bfloat16) * 0.8)(D, Hq * Dh) * D ** (-0.5)), 'wo': _w((lambda *s: torch.randn(*s, dtype=torch.bfloat16) * 0.8)(Hq * Dh, D) * (Hq * Dh) ** (-0.5))}
    _A_in = _A_setup()

    def _B_setup():
        B, S, D, F = (1, 1, 512, 1792)
        return {'x': _w((lambda *s: torch.randn(*s, dtype=torch.bfloat16) * 0.1)(B, S, D)), 'w_gate': _w((lambda *s: torch.randn(*s, dtype=torch.bfloat16) * 0.1)(D, F)), 'w_up': _w((lambda *s: torch.randn(*s, dtype=torch.bfloat16) * 0.1)(D, F)), 'w_down': _w((lambda *s: torch.randn(*s, dtype=torch.bfloat16) * 0.1)(F, D))}
    _B_in = _B_setup()
    return {'A_x': _A_in['x'], 'A_k_cache': _A_in['k_cache'], 'A_v_cache': _A_in['v_cache'], 'A_wq': _A_in['wq'], 'A_wo': _A_in['wo'], 'B_x': _B_in['x'], 'B_w_gate': _B_in['w_gate'], 'B_w_up': _B_in['w_up'], 'B_w_down': _B_in['w_down'], 'c': _w((lambda *s: torch.randn(*s, dtype=torch.bfloat16) * 0.4)(1, 512) * 8.0), 'w_mod': _w((lambda *s: torch.randn(*s, dtype=torch.bfloat16) * 0.4)(512, 6 * 512) * 512 ** (-0.5) * 8.0)}

def reference(A_x, A_k_cache, A_v_cache, A_wq, A_wo, B_x, B_w_gate, B_w_up, B_w_down, c, w_mod):

    def _A_ref(x, k_cache, v_cache, wq, wo):
        B, Sq, D = x.shape
        Hq, Dh = (32, 128)
        Hkv = k_cache.shape[1]
        rep = Hq // Hkv
        q = (lambda x, *d: x.permute(*d))((x @ wq).reshape(B, Sq, Hq, Dh), 0, 2, 1, 3)
        k = (lambda x, n, axis: torch.repeat_interleave(x, n, dim=axis))(k_cache, rep, axis=1)
        v = (lambda x, n, axis: torch.repeat_interleave(x, n, dim=axis))(v_cache, rep, axis=1)
        scores = torch.einsum('bhqd,bhkd->bhqk', q, k) * Dh ** (-0.5)
        p = _softmax(scores, axis=-1)
        o = torch.einsum('bhqk,bhkd->bhqd', p, v)
        return (lambda x, *d: x.permute(*d))(o, 0, 2, 1, 3).reshape(B, Sq, Hq * Dh) @ wo

    def _B_ref(x, w_gate, w_up, w_down):
        return _gelu(x @ w_gate) * (x @ w_up) @ w_down
    x = A_x
    mod = (_silu(c) @ w_mod).reshape(c.shape[0], 6, 1, -1)
    sa, ca, ga, sb, cb, gb = (mod[:, 0].clone(), mod[:, 1].clone(), mod[:, 2].clone(), mod[:, 3].clone(), mod[:, 4].clone(), mod[:, 5].clone())
    h = _layernorm(x, axis=-1) * (1 + ca) + sa
    x = x + ga * _A_ref(h, A_k_cache, A_v_cache, A_wq, A_wo)
    h = _layernorm(x, axis=-1) * (1 + cb) + sb
    x = x + gb * _B_ref(h, B_w_gate, B_w_up, B_w_down)
    return x
```

```asm
; @launch grid=(256,1,1) block=(768,1,1) lds=96256
.amdgcn_target "amdgcn-amd-amdhsa--gfx950"
.text
.globl adaLN_cond__gqa_block_cached__geglu_ffn__decode_kernel
.p2align 8
.type adaLN_cond__gqa_block_cached__geglu_ffn__decode_kernel,@function
adaLN_cond__gqa_block_cached__geglu_ffn__decode_kernel:
    s_cmp_ge_u32 s2, 256
    s_cbranch_scc1 L_exit
    s_load_dwordx16 s[16:31], s[0:1], 0
    s_load_dwordx8 s[32:39], s[0:1], 64
    s_load_dwordx4 s[40:43], s[0:1], 96
    v_lshrrev_b32 v1, 6, v0
    v_and_b32 v0, 63, v0
    s_and_b32 s4, s2, 7
    v_readfirstlane_b32 s3, v1
    s_lshr_b32 s5, s2, 3
    v_lshrrev_b32 v2, 4, v0
    v_bfe_u32 v3, v0, 2, 2
    v_and_b32 v4, 3, v0
    v_mov_b32 v5, 0
    s_mov_b32 s6, 1
    s_lshr_b32 s44, s5, 3
    s_and_b32 s45, s5, 7
    s_lshl_b32 s58, s4, 22
    s_lshl_b32 s59, s5, 17
    s_add_u32 s58, s58, s59
    s_cmp_ge_u32 s3, 8
    s_cbranch_scc1 L_vwave
    s_cmp_ge_u32 s3, 4
    s_cbranch_scc1 L_kwave
L_helper:
    s_setprio 3
    v_lshlrev_b32 v6, 4, v0
    v_lshlrev_b32 v7, 2, v0
    s_cmp_lg_u32 s3, 0
    s_cbranch_scc1 L_h_noinit
    ds_write_b32 v7, v5
L_h_noinit:
    v_lshrrev_b32 v8, 3, v0
    v_and_b32 v9, 7, v0
    v_lshlrev_b32 v9, 4, v9
    s_movk_i32 s59, 6144
    v_mad_u32_u24 v10, v8, s59, v9
    v_lshl_add_u32 v11, v8, 13, v9
    s_bitcmp1_b32 s4, 0
    s_mov_b32 s46, 0x6543f210
    s_mov_b32 s47, 0x43f2f1f0
    s_cselect_b32 s46, s47, s46
    s_cselect_b32 s47, 5, 7
    s_cselect_b32 s61, 28, 0
    s_lshl_b32 s59, s45, 2
    s_lshr_b32 s46, s46, s59
    s_and_b32 s46, s46, 15
    s_mul_i32 s47, s47, s44
    s_lshr_b32 s59, s4, 1
    s_mul_i32 s59, s59, 48
    s_add_u32 s59, s59, s61
    s_add_u32 s59, s59, s47
    s_cmp_eq_u32 s46, 15
    s_cselect_b32 s59, 240, s59
    s_add_u32 s46, s46, s59
    s_mov_b32 s65, s46
    s_and_b32 s47, s46, 3
    s_lshr_b32 s46, s46, 2
    s_lshl_b32 s59, s47, 2
    s_add_u32 s59, s59, s3
    s_mul_i32 s59, s59, 196608
    s_lshl_b32 s60, s46, 7
    s_add_u32 s59, s59, s60
    s_lshl_b32 s60, s44, 2
    s_add_u32 s60, s60, s3
    s_lshl_b32 s60, s60, 18
    s_lshl_b32 s61, s4, 10
    s_add_u32 s60, s60, s61
    s_lshl_b32 s61, s45, 7
    s_add_u32 s60, s60, s61
    s_lshl_b32 s62, s3, 12
    s_lshl_b32 s66, s47, 8
    s_lshl_b32 s67, s44, 8
    s_waitcnt lgkmcnt(0)
    s_mov_b32 s8, s36
    s_mov_b32 s9, s37
    s_mov_b32 s10, 0x300000
    s_mov_b32 s11, 0x20000
    s_mov_b32 s12, s42
    s_mov_b32 s13, s43
    s_mov_b32 s14, 0x1000000
    s_mov_b32 s15, 0x20000
    s_mov_b32 s48, s34
    s_mov_b32 s49, s35
    s_mov_b32 s50, 0x400
    s_mov_b32 s51, 0x20000
    s_load_dword s7, s[42:43], 0
    s_cmp_ge_u32 s65, 192
    s_cbranch_scc1 L_h_nomod1
    buffer_load_dword v12, v7, s[48:51], s66 offen
    s_add_u32 s63, s62, 30720
    s_mov_b32 m0, s63
    s_nop 0
    buffer_load_dwordx4 v10, s[8:11], s59 offen nt lds
    s_add_u32 s59, s59, 49152
    s_add_u32 s63, s63, 1024
    s_mov_b32 m0, s63
    s_nop 0
    buffer_load_dwordx4 v10, s[8:11], s59 offen nt lds
    s_add_u32 s59, s59, 49152
    s_add_u32 s63, s63, 1024
    s_mov_b32 m0, s63
    s_nop 0
    buffer_load_dwordx4 v10, s[8:11], s59 offen nt lds
    s_add_u32 s59, s59, 49152
    s_add_u32 s63, s63, 1024
    s_mov_b32 m0, s63
    s_nop 0
    buffer_load_dwordx4 v10, s[8:11], s59 offen nt lds
    s_add_u32 s59, s59, 49152
    s_add_u32 s63, s63, 1024
L_h_nomod1:
    s_mov_b32 s8, s22
    s_mov_b32 s9, s23
    s_mov_b32 s10, 0x400000
    s_mov_b32 s11, 0x20000
    s_mov_b32 s48, s16
    s_mov_b32 s49, s17
    s_mov_b32 s50, 0x400
    s_mov_b32 s51, 0x20000
    buffer_load_dwordx4 v[152:155], v6, s[48:51], 0 offen
    buffer_load_dword v156, v7, s[48:51], s67 offen
    s_barrier
    s_branch L_h2
L_vwave:
    s_sub_u32 s60, s3, 8
    s_lshl_b32 s59, s60, 10
    s_add_u32 s58, s58, s59
    v_lshlrev_b32 v6, 4, v0
    v_add_u32 v1, s58, v6
    s_cmp_eq_u32 s60, 1
    s_cbranch_scc0 L_vnopf
    s_getpc_b64 s[62:63]
L_pc_ref:
    s_sub_u32 s62, s62, L_pc_ref-adaLN_cond__gqa_block_cached__geglu_ffn__decode_kernel
    s_subb_u32 s63, s63, 0
    v_lshlrev_b32 v7, 7, v0
    s_lshl_b32 s59, s5, 10
    v_add_u32 v7, s59, v7
    s_mov_b64 exec, 0xff
    global_load_dword v40, v7, s[62:63]
    s_mov_b64 exec, -1
L_vnopf:
    s_waitcnt lgkmcnt(0)
    s_mov_b32 s8, s20
    s_mov_b32 s9, s21
    s_mov_b32 s10, 0x2000000
    s_mov_b32 s11, 0x20000
    s_mov_b32 s12, s42
    s_mov_b32 s13, s43
    s_mov_b32 s14, 0x1000000
    s_mov_b32 s15, 0x20000
    s_cmp_eq_u32 s60, 0
    s_cbranch_scc1 L_v0
L_vbar:
    s_barrier
    s_cmp_lg_u32 s2, 0
    s_cbranch_scc1 L_vmain
    s_cmp_eq_u32 s60, 3
    s_cbranch_scc1 L_probe
    s_branch L_vmain
L_v0:
    s_load_dword s7, s[42:43], 0
    v_mov_b32 v8, -1
    v_mov_b32 v9, -1
    v_mov_b32 v10, -1
    v_mov_b32 v11, -1
    s_mul_i32 s61, s4, 90112
    s_add_u32 s61, s61, 1048576
    s_lshl_b32 s62, s5, 11
    s_add_u32 s62, s62, s61
    s_add_u32 s62, s62, 24576
    s_mul_i32 s63, s5, 768
    s_add_u32 s63, s63, s61
    buffer_store_dwordx4 v[8:11], v6, s[12:15], s62 offen
    buffer_store_dwordx4 v[8:11], v6, s[12:15], s62 offen offset:1024
    s_mov_b32 s64, -1
    s_mov_b32 s65, 0xffff
    s_mov_b64 exec, s[64:65]
    buffer_store_dwordx4 v[8:11], v6, s[12:15], s63 offen
    s_mov_b64 exec, -1
    s_lshl_b32 s64, s2, 11
    s_add_u32 s64, s64, 262144
    buffer_store_dwordx4 v[8:11], v6, s[12:15], s64 offen sc1
    buffer_store_dwordx4 v[8:11], v6, s[12:15], s64 offen offset:1024 sc1
    s_cmp_lg_u32 s45, s4
    s_cbranch_scc1 L_v0_nox
    s_lshl_b32 s64, s5, 11
    s_add_u32 s64, s64, 131072
    buffer_store_dwordx4 v[8:11], v6, s[12:15], s64 offen sc1
    buffer_store_dwordx4 v[8:11], v6, s[12:15], s64 offen offset:1024 sc1
L_v0_nox:
    s_getreg_b32 s66, hwreg(HW_REG_XCC_ID)
    s_barrier
    s_branch L_v0b
L_kwave:
    s_sub_u32 s60, s3, 4
    s_lshl_b32 s59, s60, 10
    s_add_u32 s58, s58, s59
    v_lshlrev_b32 v6, 8, v3
    v_lshl_add_u32 v6, v2, 6, v6
    v_lshl_add_u32 v6, v4, 4, v6
    v_add_u32 v1, s58, v6
    s_waitcnt lgkmcnt(0)
    s_mov_b32 s8, s18
    s_mov_b32 s9, s19
    s_mov_b32 s10, 0x2000000
    s_mov_b32 s11, 0x20000
    buffer_load_dwordx4 v[40:43], v6, s[8:11], s58 offen nt
    s_add_u32 s58, s58, 4096
    buffer_load_dwordx4 v[44:47], v6, s[8:11], s58 offen nt
    s_add_u32 s58, s58, 4096
    s_sleep 3
    buffer_load_dwordx4 v[48:51], v6, s[8:11], s58 offen nt
    s_add_u32 s58, s58, 4096
    buffer_load_dwordx4 v[52:55], v6, s[8:11], s58 offen nt
    s_add_u32 s58, s58, 4096
    buffer_load_dwordx4 v[56:59], v6, s[8:11], s58 offen nt
    s_add_u32 s58, s58, 4096
    s_barrier
    s_mov_b32 s12, s42
    s_mov_b32 s13, s43
    s_mov_b32 s14, 0x1000000
    s_mov_b32 s15, 0x20000
    s_waitcnt vmcnt(4)
    buffer_load_dwordx4 v[60:63], v6, s[8:11], s58 offen nt
    s_add_u32 s58, s58, 4096
    s_waitcnt vmcnt(4)
    buffer_load_dwordx4 v[64:67], v6, s[8:11], s58 offen nt
    s_add_u32 s58, s58, 4096
    s_waitcnt vmcnt(4)
    buffer_load_dwordx4 v[68:71], v6, s[8:11], s58 offen nt
    s_add_u32 s58, s58, 4096
    s_waitcnt vmcnt(4)
    buffer_load_dwordx4 v[72:75], v6, s[8:11], s58 offen nt
    s_add_u32 s58, s58, 4096
    s_waitcnt vmcnt(4)
    buffer_load_dwordx4 v[76:79], v6, s[8:11], s58 offen nt
    s_add_u32 s58, s58, 4096
    s_waitcnt vmcnt(4)
    buffer_load_dwordx4 v[80:83], v6, s[8:11], s58 offen nt
    s_add_u32 s58, s58, 4096
    s_waitcnt vmcnt(4)
    buffer_load_dwordx4 v[84:87], v6, s[8:11], s58 offen nt
    s_add_u32 s58, s58, 4096
    s_waitcnt vmcnt(4)
    buffer_load_dwordx4 v[88:91], v6, s[8:11], s58 offen nt
    s_add_u32 s58, s58, 4096
    s_waitcnt vmcnt(4)
    buffer_load_dwordx4 v[92:95], v6, s[8:11], s58 offen nt
    s_add_u32 s58, s58, 4096
    s_waitcnt vmcnt(4)
    buffer_load_dwordx4 v[96:99], v6, s[8:11], s58 offen nt
    s_add_u32 s58, s58, 4096
    s_waitcnt vmcnt(4)
    buffer_load_dwordx4 v[100:103], v6, s[8:11], s58 offen nt
    s_add_u32 s58, s58, 4096
    s_waitcnt vmcnt(4)
    buffer_load_dwordx4 v[104:107], v6, s[8:11], s58 offen nt
    s_add_u32 s58, s58, 4096
    s_waitcnt vmcnt(4)
    buffer_load_dwordx4 v[108:111], v6, s[8:11], s58 offen nt
    s_add_u32 s58, s58, 4096
    s_waitcnt vmcnt(4)
    buffer_load_dwordx4 v[112:115], v6, s[8:11], s58 offen nt
    s_add_u32 s58, s58, 4096
    s_waitcnt vmcnt(4)
    buffer_load_dwordx4 v[116:119], v6, s[8:11], s58 offen nt
    s_add_u32 s58, s58, 4096
    s_waitcnt vmcnt(4)
    buffer_load_dwordx4 v[120:123], v6, s[8:11], s58 offen nt
    s_add_u32 s58, s58, 4096
    s_waitcnt vmcnt(4)
    buffer_load_dwordx4 v[124:127], v6, s[8:11], s58 offen nt
    s_add_u32 s58, s58, 4096
    s_waitcnt vmcnt(4)
    buffer_load_dwordx4 v[128:131], v6, s[8:11], s58 offen nt
    s_add_u32 s58, s58, 4096
    s_waitcnt vmcnt(4)
    buffer_load_dwordx4 v[132:135], v6, s[8:11], s58 offen nt
    s_add_u32 s58, s58, 4096
    s_waitcnt vmcnt(4)
    buffer_load_dwordx4 v[136:139], v6, s[8:11], s58 offen nt
    s_add_u32 s58, s58, 4096
    s_waitcnt vmcnt(4)
    buffer_load_dwordx4 v[140:143], v6, s[8:11], s58 offen nt
    s_add_u32 s58, s58, 4096
    s_waitcnt vmcnt(4)
    buffer_load_dwordx4 v[144:147], v6, s[8:11], s58 offen nt
    s_add_u32 s58, s58, 4096
    s_waitcnt vmcnt(4)
    buffer_load_dwordx4 v[148:151], v6, s[8:11], s58 offen nt
    s_add_u32 s58, s58, 4096
    s_waitcnt vmcnt(4)
    buffer_load_dwordx4 v[152:155], v6, s[8:11], s58 offen nt
    s_add_u32 s58, s58, 4096
    s_waitcnt vmcnt(4)
    buffer_load_dwordx4 v[156:159], v6, s[8:11], s58 offen nt
    s_add_u32 s58, s58, 4096
    s_waitcnt vmcnt(4)
    buffer_load_dwordx4 v[160:163], v6, s[8:11], s58 offen nt
    s_add_u32 s58, s58, 4096
    s_waitcnt vmcnt(4)
    buffer_load_dwordx4 v[164:167], v6, s[8:11], s58 offen nt
    s_add_u32 s58, s58, 4096
    s_waitcnt vmcnt(2)
    s_lshl_b32 s59, s60, 2
    v_mov_b32 v30, s59
    v_mov_b32 v7, 1
    ds_write_b32 v30, v7 offset:16
    v_lshlrev_b32 v7, 8, v4
    v_lshl_add_u32 v7, v2, 6, v7
    v_lshl_add_u32 v7, v3, 4, v7
    s_mov_b32 s54, 0
L_lw_1:
    ds_read_b32 v8, v5 offset:0
    s_add_u32 s54, s54, 1
    s_waitcnt lgkmcnt(0)
    v_readfirstlane_b32 s53, v8
    s_cmp_gt_u32 s54, 1048576
    s_cbranch_scc1 L_lwd_2
    s_cmp_lg_u32 s53, 0
    s_cbranch_scc1 L_lwd_2
    s_sleep 1
    s_branch L_lw_1
L_lwd_2:
    s_mov_b32 s6, s53
    ds_read_b128 v[8:11], v7 offset:256
    s_waitcnt vmcnt(0) lgkmcnt(0)
    v_mfma_f32_16x16x32_bf16 v[40:43], v[40:43], v[8:11], 0
    v_mfma_f32_16x16x32_bf16 v[44:47], v[44:47], v[8:11], 0
    v_mfma_f32_16x16x32_bf16 v[48:51], v[48:51], v[8:11], 0
    s_nop 5
    v_mfma_f32_16x16x32_bf16 v[52:55], v[52:55], v[8:11], 0
    v_mov_b32_dpp v12, v40 quad_perm:[0,1,2,3] row_mask:0xf bank_mask:0x1
    v_add_f32_dpp v12, v41, v12 row_ror:12 row_mask:0xf bank_mask:0x1
    v_add_f32_dpp v12, v42, v12 row_ror:8 row_mask:0xf bank_mask:0x1
    v_add_f32_dpp v12, v43, v12 row_ror:4 row_mask:0xf bank_mask:0x1
    v_mfma_f32_16x16x32_bf16 v[56:59], v[56:59], v[8:11], 0
    v_mov_b32_dpp v12, v44 row_ror:4 row_mask:0xf bank_mask:0x2
    v_add_f32_dpp v12, v45, v12 quad_perm:[0,1,2,3] row_mask:0xf bank_mask:0x2
    v_add_f32_dpp v12, v46, v12 row_ror:12 row_mask:0xf bank_mask:0x2
    v_add_f32_dpp v12, v47, v12 row_ror:8 row_mask:0xf bank_mask:0x2
    v_mfma_f32_16x16x32_bf16 v[60:63], v[60:63], v[8:11], 0
    v_mov_b32_dpp v12, v48 row_ror:8 row_mask:0xf bank_mask:0x4
    v_add_f32_dpp v12, v49, v12 row_ror:4 row_mask:0xf bank_mask:0x4
    v_add_f32_dpp v12, v50, v12 quad_perm:[0,1,2,3] row_mask:0xf bank_mask:0x4
    v_add_f32_dpp v12, v51, v12 row_ror:12 row_mask:0xf bank_mask:0x4
    v_mfma_f32_16x16x32_bf16 v[64:67], v[64:67], v[8:11], 0
    v_mov_b32_dpp v12, v52 row_ror:12 row_mask:0xf bank_mask:0x8
    v_add_f32_dpp v12, v53, v12 row_ror:8 row_mask:0xf bank_mask:0x8
    v_add_f32_dpp v12, v54, v12 row_ror:4 row_mask:0xf bank_mask:0x8
    v_add_f32_dpp v12, v55, v12 quad_perm:[0,1,2,3] row_mask:0xf bank_mask:0x8
    v_mfma_f32_16x16x32_bf16 v[68:71], v[68:71], v[8:11], 0
    v_mov_b32_dpp v13, v56 quad_perm:[0,1,2,3] row_mask:0xf bank_mask:0x1
    v_add_f32_dpp v13, v57, v13 row_ror:12 row_mask:0xf bank_mask:0x1
    v_add_f32_dpp v13, v58, v13 row_ror:8 row_mask:0xf bank_mask:0x1
    v_add_f32_dpp v13, v59, v13 row_ror:4 row_mask:0xf bank_mask:0x1
    v_mfma_f32_16x16x32_bf16 v[72:75], v[72:75], v[8:11], 0
    v_mov_b32_dpp v13, v60 row_ror:4 row_mask:0xf bank_mask:0x2
    v_add_f32_dpp v13, v61, v13 quad_perm:[0,1,2,3] row_mask:0xf bank_mask:0x2
    v_add_f32_dpp v13, v62, v13 row_ror:12 row_mask:0xf bank_mask:0x2
    v_add_f32_dpp v13, v63, v13 row_ror:8 row_mask:0xf bank_mask:0x2
    v_mfma_f32_16x16x32_bf16 v[76:79], v[76:79], v[8:11], 0
    v_mov_b32_dpp v13, v64 row_ror:8 row_mask:0xf bank_mask:0x4
    v_add_f32_dpp v13, v65, v13 row_ror:4 row_mask:0xf bank_mask:0x4
    v_add_f32_dpp v13, v66, v13 quad_perm:[0,1,2,3] row_mask:0xf bank_mask:0x4
    v_add_f32_dpp v13, v67, v13 row_ror:12 row_mask:0xf bank_mask:0x4
    v_mfma_f32_16x16x32_bf16 v[80:83], v[80:83], v[8:11], 0
    v_mov_b32_dpp v13, v68 row_ror:12 row_mask:0xf bank_mask:0x8
    v_add_f32_dpp v13, v69, v13 row_ror:8 row_mask:0xf bank_mask:0x8
    v_add_f32_dpp v13, v70, v13 row_ror:4 row_mask:0xf bank_mask:0x8
    v_add_f32_dpp v13, v71, v13 quad_perm:[0,1,2,3] row_mask:0xf bank_mask:0x8
    v_mfma_f32_16x16x32_bf16 v[84:87], v[84:87], v[8:11], 0
    v_mov_b32_dpp v14, v72 quad_perm:[0,1,2,3] row_mask:0xf bank_mask:0x1
    v_add_f32_dpp v14, v73, v14 row_ror:12 row_mask:0xf bank_mask:0x1
    v_add_f32_dpp v14, v74, v14 row_ror:8 row_mask:0xf bank_mask:0x1
    v_add_f32_dpp v14, v75, v14 row_ror:4 row_mask:0xf bank_mask:0x1
    v_mfma_f32_16x16x32_bf16 v[88:91], v[88:91], v[8:11], 0
    v_mov_b32_dpp v14, v76 row_ror:4 row_mask:0xf bank_mask:0x2
    v_add_f32_dpp v14, v77, v14 quad_perm:[0,1,2,3] row_mask:0xf bank_mask:0x2
    v_add_f32_dpp v14, v78, v14 row_ror:12 row_mask:0xf bank_mask:0x2
    v_add_f32_dpp v14, v79, v14 row_ror:8 row_mask:0xf bank_mask:0x2
    v_mfma_f32_16x16x32_bf16 v[92:95], v[92:95], v[8:11], 0
    v_mov_b32_dpp v14, v80 row_ror:8 row_mask:0xf bank_mask:0x4
    v_add_f32_dpp v14, v81, v14 row_ror:4 row_mask:0xf bank_mask:0x4
    v_add_f32_dpp v14, v82, v14 quad_perm:[0,1,2,3] row_mask:0xf bank_mask:0x4
    v_add_f32_dpp v14, v83, v14 row_ror:12 row_mask:0xf bank_mask:0x4
    v_mfma_f32_16x16x32_bf16 v[96:99], v[96:99], v[8:11], 0
    v_mov_b32_dpp v14, v84 row_ror:12 row_mask:0xf bank_mask:0x8
    v_add_f32_dpp v14, v85, v14 row_ror:8 row_mask:0xf bank_mask:0x8
    v_add_f32_dpp v14, v86, v14 row_ror:4 row_mask:0xf bank_mask:0x8
    v_add_f32_dpp v14, v87, v14 quad_perm:[0,1,2,3] row_mask:0xf bank_mask:0x8
    v_mfma_f32_16x16x32_bf16 v[100:103], v[100:103], v[8:11], 0
    v_mov_b32_dpp v15, v88 quad_perm:[0,1,2,3] row_mask:0xf bank_mask:0x1
    v_add_f32_dpp v15, v89, v15 row_ror:12 row_mask:0xf bank_mask:0x1
    v_add_f32_dpp v15, v90, v15 row_ror:8 row_mask:0xf bank_mask:0x1
    v_add_f32_dpp v15, v91, v15 row_ror:4 row_mask:0xf bank_mask:0x1
    v_mfma_f32_16x16x32_bf16 v[104:107], v[104:107], v[8:11], 0
    v_mov_b32_dpp v15, v92 row_ror:4 row_mask:0xf bank_mask:0x2
    v_add_f32_dpp v15, v93, v15 quad_perm:[0,1,2,3] row_mask:0xf bank_mask:0x2
    v_add_f32_dpp v15, v94, v15 row_ror:12 row_mask:0xf bank_mask:0x2
    v_add_f32_dpp v15, v95, v15 row_ror:8 row_mask:0xf bank_mask:0x2
    v_mfma_f32_16x16x32_bf16 v[108:111], v[108:111], v[8:11], 0
    v_mov_b32_dpp v15, v96 row_ror:8 row_mask:0xf bank_mask:0x4
    v_add_f32_dpp v15, v97, v15 row_ror:4 row_mask:0xf bank_mask:0x4
    v_add_f32_dpp v15, v98, v15 quad_perm:[0,1,2,3] row_mask:0xf bank_mask:0x4
    v_add_f32_dpp v15, v99, v15 row_ror:12 row_mask:0xf bank_mask:0x4
    v_mfma_f32_16x16x32_bf16 v[112:115], v[112:115], v[8:11], 0
    v_mov_b32_dpp v15, v100 row_ror:12 row_mask:0xf bank_mask:0x8
    v_add_f32_dpp v15, v101, v15 row_ror:8 row_mask:0xf bank_mask:0x8
    v_add_f32_dpp v15, v102, v15 row_ror:4 row_mask:0xf bank_mask:0x8
    v_add_f32_dpp v15, v103, v15 quad_perm:[0,1,2,3] row_mask:0xf bank_mask:0x8
    v_mfma_f32_16x16x32_bf16 v[116:119], v[116:119], v[8:11], 0
    v_mov_b32_dpp v16, v104 quad_perm:[0,1,2,3] row_mask:0xf bank_mask:0x1
    v_add_f32_dpp v16, v105, v16 row_ror:12 row_mask:0xf bank_mask:0x1
    v_add_f32_dpp v16, v106, v16 row_ror:8 row_mask:0xf bank_mask:0x1
    v_add_f32_dpp v16, v107, v16 row_ror:4 row_mask:0xf bank_mask:0x1
    v_mfma_f32_16x16x32_bf16 v[120:123], v[120:123], v[8:11], 0
    v_mov_b32_dpp v16, v108 row_ror:4 row_mask:0xf bank_mask:0x2
    v_add_f32_dpp v16, v109, v16 quad_perm:[0,1,2,3] row_mask:0xf bank_mask:0x2
    v_add_f32_dpp v16, v110, v16 row_ror:12 row_mask:0xf bank_mask:0x2
    v_add_f32_dpp v16, v111, v16 row_ror:8 row_mask:0xf bank_mask:0x2
    v_mfma_f32_16x16x32_bf16 v[124:127], v[124:127], v[8:11], 0
    v_mov_b32_dpp v16, v112 row_ror:8 row_mask:0xf bank_mask:0x4
    v_add_f32_dpp v16, v113, v16 row_ror:4 row_mask:0xf bank_mask:0x4
    v_add_f32_dpp v16, v114, v16 quad_perm:[0,1,2,3] row_mask:0xf bank_mask:0x4
    v_add_f32_dpp v16, v115, v16 row_ror:12 row_mask:0xf bank_mask:0x4
    v_mfma_f32_16x16x32_bf16 v[128:131], v[128:131], v[8:11], 0
    v_mov_b32_dpp v16, v116 row_ror:12 row_mask:0xf bank_mask:0x8
    v_add_f32_dpp v16, v117, v16 row_ror:8 row_mask:0xf bank_mask:0x8
    v_add_f32_dpp v16, v118, v16 row_ror:4 row_mask:0xf bank_mask:0x8
    v_add_f32_dpp v16, v119, v16 quad_perm:[0,1,2,3] row_mask:0xf bank_mask:0x8
    v_mfma_f32_16x16x32_bf16 v[132:135], v[132:135], v[8:11], 0
    v_mov_b32_dpp v17, v120 quad_perm:[0,1,2,3] row_mask:0xf bank_mask:0x1
    v_add_f32_dpp v17, v121, v17 row_ror:12 row_mask:0xf bank_mask:0x1
    v_add_f32_dpp v17, v122, v17 row_ror:8 row_mask:0xf bank_mask:0x1
    v_add_f32_dpp v17, v123, v17 row_ror:4 row_mask:0xf bank_mask:0x1
    v_mfma_f32_16x16x32_bf16 v[136:139], v[136:139], v[8:11], 0
    v_mov_b32_dpp v17, v124 row_ror:4 row_mask:0xf bank_mask:0x2
    v_add_f32_dpp v17, v125, v17 quad_perm:[0,1,2,3] row_mask:0xf bank_mask:0x2
    v_add_f32_dpp v17, v126, v17 row_ror:12 row_mask:0xf bank_mask:0x2
    v_add_f32_dpp v17, v127, v17 row_ror:8 row_mask:0xf bank_mask:0x2
    v_mfma_f32_16x16x32_bf16 v[140:143], v[140:143], v[8:11], 0
    v_mov_b32_dpp v17, v128 row_ror:8 row_mask:0xf bank_mask:0x4
    v_add_f32_dpp v17, v129, v17 row_ror:4 row_mask:0xf bank_mask:0x4
    v_add_f32_dpp v17, v130, v17 quad_perm:[0,1,2,3] row_mask:0xf bank_mask:0x4
    v_add_f32_dpp v17, v131, v17 row_ror:12 row_mask:0xf bank_mask:0x4
    v_mfma_f32_16x16x32_bf16 v[144:147], v[144:147], v[8:11], 0
    v_mov_b32_dpp v17, v132 row_ror:12 row_mask:0xf bank_mask:0x8
    v_add_f32_dpp v17, v133, v17 row_ror:8 row_mask:0xf bank_mask:0x8
    v_add_f32_dpp v17, v134, v17 row_ror:4 row_mask:0xf bank_mask:0x8
    v_add_f32_dpp v17, v135, v17 quad_perm:[0,1,2,3] row_mask:0xf bank_mask:0x8
    v_mfma_f32_16x16x32_bf16 v[148:151], v[148:151], v[8:11], 0
    v_mov_b32_dpp v18, v136 quad_perm:[0,1,2,3] row_mask:0xf bank_mask:0x1
    v_add_f32_dpp v18, v137, v18 row_ror:12 row_mask:0xf bank_mask:0x1
    v_add_f32_dpp v18, v138, v18 row_ror:8 row_mask:0xf bank_mask:0x1
    v_add_f32_dpp v18, v139, v18 row_ror:4 row_mask:0xf bank_mask:0x1
    v_mfma_f32_16x16x32_bf16 v[152:155], v[152:155], v[8:11], 0
    v_mov_b32_dpp v18, v140 row_ror:4 row_mask:0xf bank_mask:0x2
    v_add_f32_dpp v18, v141, v18 quad_perm:[0,1,2,3] row_mask:0xf bank_mask:0x2
    v_add_f32_dpp v18, v142, v18 row_ror:12 row_mask:0xf bank_mask:0x2
    v_add_f32_dpp v18, v143, v18 row_ror:8 row_mask:0xf bank_mask:0x2
    v_mfma_f32_16x16x32_bf16 v[156:159], v[156:159], v[8:11], 0
    v_mov_b32_dpp v18, v144 row_ror:8 row_mask:0xf bank_mask:0x4
    v_add_f32_dpp v18, v145, v18 row_ror:4 row_mask:0xf bank_mask:0x4
    v_add_f32_dpp v18, v146, v18 quad_perm:[0,1,2,3] row_mask:0xf bank_mask:0x4
    v_add_f32_dpp v18, v147, v18 row_ror:12 row_mask:0xf bank_mask:0x4
    v_mfma_f32_16x16x32_bf16 v[160:163], v[160:163], v[8:11], 0
    v_mov_b32_dpp v18, v148 row_ror:12 row_mask:0xf bank_mask:0x8
    v_add_f32_dpp v18, v149, v18 row_ror:8 row_mask:0xf bank_mask:0x8
    v_add_f32_dpp v18, v150, v18 row_ror:4 row_mask:0xf bank_mask:0x8
    v_add_f32_dpp v18, v151, v18 quad_perm:[0,1,2,3] row_mask:0xf bank_mask:0x8
    v_mfma_f32_16x16x32_bf16 v[164:167], v[164:167], v[8:11], 0
    v_mov_b32_dpp v19, v152 quad_perm:[0,1,2,3] row_mask:0xf bank_mask:0x1
    v_add_f32_dpp v19, v153, v19 row_ror:12 row_mask:0xf bank_mask:0x1
    v_add_f32_dpp v19, v154, v19 row_ror:8 row_mask:0xf bank_mask:0x1
    v_add_f32_dpp v19, v155, v19 row_ror:4 row_mask:0xf bank_mask:0x1
    s_nop 3
    v_mov_b32_dpp v19, v156 row_ror:4 row_mask:0xf bank_mask:0x2
    v_add_f32_dpp v19, v157, v19 quad_perm:[0,1,2,3] row_mask:0xf bank_mask:0x2
    v_add_f32_dpp v19, v158, v19 row_ror:12 row_mask:0xf bank_mask:0x2
    v_add_f32_dpp v19, v159, v19 row_ror:8 row_mask:0xf bank_mask:0x2
    v_mov_b32_dpp v19, v160 row_ror:8 row_mask:0xf bank_mask:0x4
    v_add_f32_dpp v19, v161, v19 row_ror:4 row_mask:0xf bank_mask:0x4
    v_add_f32_dpp v19, v162, v19 quad_perm:[0,1,2,3] row_mask:0xf bank_mask:0x4
    v_add_f32_dpp v19, v163, v19 row_ror:12 row_mask:0xf bank_mask:0x4
    v_mov_b32_dpp v19, v164 row_ror:12 row_mask:0xf bank_mask:0x8
    v_add_f32_dpp v19, v165, v19 row_ror:8 row_mask:0xf bank_mask:0x8
    v_add_f32_dpp v19, v166, v19 row_ror:4 row_mask:0xf bank_mask:0x8
    v_add_f32_dpp v19, v167, v19 quad_perm:[0,1,2,3] row_mask:0xf bank_mask:0x8
    v_cvt_pk_bf16_f32 v20, v12, v13
    v_lshlrev_b32 v12, 16, v20
    v_and_b32 v13, 0xffff0000, v20
    v_mul_f32 v12, 0x3db504f3, v12
    v_mul_f32 v13, 0x3db504f3, v13
    v_cvt_pk_bf16_f32 v20, v12, v13
    v_lshlrev_b32 v12, 16, v20
    v_and_b32 v13, 0xffff0000, v20
    v_cvt_pk_bf16_f32 v20, v14, v15
    v_lshlrev_b32 v14, 16, v20
    v_and_b32 v15, 0xffff0000, v20
    v_mul_f32 v14, 0x3db504f3, v14
    v_mul_f32 v15, 0x3db504f3, v15
    v_cvt_pk_bf16_f32 v20, v14, v15
    v_lshlrev_b32 v14, 16, v20
    v_and_b32 v15, 0xffff0000, v20
    v_cvt_pk_bf16_f32 v20, v16, v17
    v_lshlrev_b32 v16, 16, v20
    v_and_b32 v17, 0xffff0000, v20
    v_mul_f32 v16, 0x3db504f3, v16
    v_mul_f32 v17, 0x3db504f3, v17
    v_cvt_pk_bf16_f32 v20, v16, v17
    v_lshlrev_b32 v16, 16, v20
    v_and_b32 v17, 0xffff0000, v20
    v_cvt_pk_bf16_f32 v20, v18, v19
    v_lshlrev_b32 v18, 16, v20
    v_and_b32 v19, 0xffff0000, v20
    v_mul_f32 v18, 0x3db504f3, v18
    v_mul_f32 v19, 0x3db504f3, v19
    v_cvt_pk_bf16_f32 v20, v18, v19
    v_lshlrev_b32 v18, 16, v20
    v_and_b32 v19, 0xffff0000, v20
    v_max3_f32 v22, v12, v13, v14
    v_max3_f32 v22, v22, v15, v16
    v_max3_f32 v22, v22, v17, v18
    v_max_f32 v22, v22, v19
    s_nop 1
    v_max_f32_dpp v22, v22, v22 row_ror:4 row_mask:0xf bank_mask:0xf
    s_nop 1
    v_max_f32_dpp v22, v22, v22 row_ror:8 row_mask:0xf bank_mask:0xf
    v_mov_b32 v20, v22
    s_nop 1
    v_permlane16_swap_b32 v22, v20
    v_max_f32 v22, v22, v20
    v_mov_b32 v20, v22
    s_nop 1
    v_permlane32_swap_b32 v22, v20
    v_max_f32 v22, v22, v20
    v_sub_f32 v12, v12, v22
    v_sub_f32 v13, v13, v22
    v_sub_f32 v14, v14, v22
    v_sub_f32 v15, v15, v22
    v_sub_f32 v16, v16, v22
    v_sub_f32 v17, v17, v22
    v_sub_f32 v18, v18, v22
    v_sub_f32 v19, v19, v22
    v_mul_f32 v12, 0x3fb8aa3b, v12
    v_mul_f32 v13, 0x3fb8aa3b, v13
    v_mul_f32 v14, 0x3fb8aa3b, v14
    v_mul_f32 v15, 0x3fb8aa3b, v15
    v_mul_f32 v16, 0x3fb8aa3b, v16
    v_mul_f32 v17, 0x3fb8aa3b, v17
    v_mul_f32 v18, 0x3fb8aa3b, v18
    v_mul_f32 v19, 0x3fb8aa3b, v19
    v_exp_f32 v12, v12
    v_exp_f32 v13, v13
    v_exp_f32 v14, v14
    v_exp_f32 v15, v15
    v_exp_f32 v16, v16
    v_exp_f32 v17, v17
    v_exp_f32 v18, v18
    v_exp_f32 v19, v19
    s_nop 0
    v_add_f32 v23, v12, v13
    v_add_f32 v23, v23, v14
    v_add_f32 v23, v23, v15
    v_add_f32 v23, v23, v16
    v_add_f32 v23, v23, v17
    v_add_f32 v23, v23, v18
    v_add_f32 v23, v23, v19
    s_nop 1
    v_add_f32_dpp v23, v23, v23 row_ror:4 row_mask:0xf bank_mask:0xf
    s_nop 1
    v_add_f32_dpp v23, v23, v23 row_ror:8 row_mask:0xf bank_mask:0xf
    v_mov_b32 v20, v23
    s_nop 1
    v_permlane16_swap_b32 v23, v20
    v_add_f32 v23, v23, v20
    v_mov_b32 v20, v23
    s_nop 1
    v_permlane32_swap_b32 v23, v20
    v_add_f32 v23, v23, v20
    s_lshl_b32 s59, s60, 5
    v_lshl_add_u32 v24, v4, 3, s59
    v_mov_b32 v25, 1
    s_mov_b64 exec, 0xf
    ds_write_b64 v24, v[22:23] offset:64
    s_mov_b64 exec, 1
    ds_add_rtn_u32 v25, v5, v25 offset:52
    s_mov_b64 exec, -1
    v_lshlrev_b32 v24, 3, v4
    v_lshl_add_u32 v26, v3, 5, v24
    s_lshl_b32 s61, s6, 20
    s_mul_i32 s59, s4, 90112
    s_add_u32 s61, s61, s59
    s_add_u32 s61, s61, 4096
    s_waitcnt lgkmcnt(0)
    v_readfirstlane_b32 s53, v25
    s_cmp_lg_u32 s53, 3
    s_cbranch_scc1 L_k_waitst
    ds_read_b64 v[40:41], v26 offset:64
    s_waitcnt lgkmcnt(0)
    v_max_f32_dpp v42, v40, v40 row_ror:4 row_mask:0xf bank_mask:0xf
    v_mov_b32 v31, v40
    s_nop 0
    v_max_f32_dpp v42, v42, v42 row_ror:8 row_mask:0xf bank_mask:0xf
    v_sub_f32 v40, v40, v42
    v_mul_f32 v40, 0x3fb8aa3b, v40
    v_exp_f32 v40, v40
    s_nop 0
    v_mul_f32 v43, v40, v41
    s_nop 1
    v_add_f32_dpp v43, v43, v43 row_ror:4 row_mask:0xf bank_mask:0xf
    s_nop 1
    v_add_f32_dpp v43, v43, v43 row_ror:8 row_mask:0xf bank_mask:0xf
    s_lshr_b32 s59, s5, 1
    s_lshl_b32 s59, s59, 6
    s_and_b32 s62, s5, 1
    s_lshl_b32 s62, s62, 3
    s_add_u32 s59, s59, s62
    s_add_u32 s59, s59, s61
    v_lshlrev_b32 v27, 4, v0
    s_mov_b64 exec, 0xf
    s_cmp_eq_u32 s6, 1
    s_cbranch_scc0 L_slow_3
    buffer_store_dwordx2 v[42:43], v27, s[12:15], s59 offen
L_back_4:
    s_mov_b64 exec, -1
    s_mov_b32 s54, 0
L_poll_5:
    buffer_load_dwordx4 v[40:43], v27, s[12:15], s61 offen sc1
    s_waitcnt vmcnt(0)
    v_max3_u32 v20, v40, v41, v42
    v_max_u32 v20, v20, v43
    v_cmp_eq_u32 vcc, -1, v20
    s_add_u32 s54, s54, 1
    s_cmp_gt_u32 s54, 262144
    s_cbranch_scc1 L_pd_6
    s_cbranch_vccnz L_poll_5
L_pd_6:
    v_max_f32 v28, v40, v42
    s_nop 1
    v_max_f32_dpp v28, v28, v28 row_ror:4 row_mask:0xf bank_mask:0xf
    s_nop 1
    v_max_f32_dpp v28, v28, v28 row_ror:8 row_mask:0xf bank_mask:0xf
    v_mov_b32 v20, v28
    s_nop 1
    v_permlane16_swap_b32 v28, v20
    v_max_f32 v28, v28, v20
    v_mov_b32 v20, v28
    s_nop 1
    v_permlane32_swap_b32 v28, v20
    v_max_f32 v28, v28, v20
    v_sub_f32 v40, v40, v28
    v_sub_f32 v42, v42, v28
    v_mul_f32 v40, 0x3fb8aa3b, v40
    v_mul_f32 v42, 0x3fb8aa3b, v42
    v_exp_f32 v40, v40
    v_exp_f32 v42, v42
    s_nop 0
    v_mul_f32 v29, v40, v41
    v_fmac_f32 v29, v42, v43
    s_nop 1
    v_add_f32_dpp v29, v29, v29 row_ror:4 row_mask:0xf bank_mask:0xf
    s_nop 1
    v_add_f32_dpp v29, v29, v29 row_ror:8 row_mask:0xf bank_mask:0xf
    v_mov_b32 v20, v29
    s_nop 1
    v_permlane16_swap_b32 v29, v20
    v_add_f32 v29, v29, v20
    v_mov_b32 v20, v29
    s_nop 1
    v_permlane32_swap_b32 v29, v20
    v_add_f32 v29, v29, v20
    v_rcp_f32 v29, v29
    v_mov_b32 v25, 1
    s_mov_b64 exec, 0xf
    ds_write_b64 v24, v[28:29] offset:192
    ds_write_b32 v5, v25 offset:56
    s_mov_b64 exec, -1
    s_branch L_k_havest
L_k_waitst:
    s_mov_b32 s54, 0
L_lw_7:
    ds_read_b32 v25, v5 offset:56
    s_add_u32 s54, s54, 1
    s_waitcnt lgkmcnt(0)
    v_readfirstlane_b32 s53, v25
    s_cmp_gt_u32 s54, 1048576
    s_cbranch_scc1 L_lwd_8
    s_cmp_lg_u32 s53, 0
    s_cbranch_scc1 L_lwd_8
    s_sleep 1
    s_branch L_lw_7
L_lwd_8:
    ds_read_b64 v[28:29], v24 offset:192
    s_waitcnt lgkmcnt(0)
L_k_havest:
    v_sub_f32 v22, v22, v28
    v_mul_f32 v22, 0x3fb8aa3b, v22
    v_exp_f32 v22, v22
    s_nop 0
    v_mul_f32 v22, v22, v29
    v_lshl_add_u32 v25, v2, 2, v4
    v_mul_u32_u24 v25, 144, v25
    v_lshl_add_u32 v25, v3, 2, v25
    s_mul_i32 s59, s60, 2304
    v_add_u32 v25, s59, v25
    v_mul_f32 v12, v12, v22
    v_cvt_pk_bf16_f32 v32, v12, v12
    ds_write_b32 v25, v32 offset:2560
    v_mul_f32 v13, v13, v22
    v_cvt_pk_bf16_f32 v33, v13, v13
    ds_write_b32 v25, v33 offset:2576
    v_mul_f32 v14, v14, v22
    v_cvt_pk_bf16_f32 v34, v14, v14
    ds_write_b32 v25, v34 offset:2592
    v_mul_f32 v15, v15, v22
    v_cvt_pk_bf16_f32 v35, v15, v15
    ds_write_b32 v25, v35 offset:2608
    v_mul_f32 v16, v16, v22
    v_cvt_pk_bf16_f32 v36, v16, v16
    ds_write_b32 v25, v36 offset:2624
    v_mul_f32 v17, v17, v22
    v_cvt_pk_bf16_f32 v37, v17, v17
    ds_write_b32 v25, v37 offset:2640
    v_mul_f32 v18, v18, v22
    v_cvt_pk_bf16_f32 v38, v18, v18
    ds_write_b32 v25, v38 offset:2656
    v_mul_f32 v19, v19, v22
    v_cvt_pk_bf16_f32 v39, v19, v19
    ds_write_b32 v25, v39 offset:2672
    v_mov_b32 v7, 2
    ds_write_b32 v30, v7 offset:16
    s_waitcnt lgkmcnt(0)
    s_cmp_eq_u32 s60, 0
    s_cbranch_scc1 L_reducer
    s_endpgm
L_reducer:
    s_setprio 3
    v_lshlrev_b32 v6, 4, v0
    v_and_b32 v20, 1, v2
    v_lshlrev_b32 v20, 1, v20
    v_lshrrev_b32 v21, 1, v2
    v_or_b32 v20, v20, v21
    v_lshl_add_u32 v21, v4, 2, v20
    v_add_u32 v22, s4, v20
    v_and_b32 v22, 3, v22
    v_lshl_add_u32 v22, v22, 2, v4
    s_lshl_b32 s59, s5, 4
    v_add_lshl_u32 v21, v21, s59, 1
    v_add_lshl_u32 v22, v22, s59, 1
    s_lshl_b32 s61, s6, 20
    s_mul_i32 s59, s4, 90112
    s_add_u32 s61, s61, s59
    s_lshl_b32 s59, s5, 11
    s_add_u32 s62, s59, s61
    s_add_u32 s62, s62, 24576
    s_add_u32 s64, s59, 131072
    s_lshl_b32 s63, s2, 11
    s_add_u32 s63, s63, 262144
    s_mov_b32 s50, 0x000f000f
    s_mov_b32 s51, 0x000f000f
    s_mov_b32 s8, s38
    s_mov_b32 s9, s39
    s_mov_b32 s10, 0x400
    s_mov_b32 s11, 0x20000
    s_mov_b32 s54, 0
L_lw_9:
    ds_read_b32 v8, v5 offset:60
    s_add_u32 s54, s54, 1
    s_waitcnt lgkmcnt(0)
    v_readfirstlane_b32 s53, v8
    s_cmp_gt_u32 s54, 1048576
    s_cbranch_scc1 L_lwd_10
    s_cmp_ge_u32 s53, 3
    s_cbranch_scc1 L_lwd_10
    s_sleep 4
    s_branch L_lw_9
L_lwd_10:
    ds_read_b128 v[24:27], v6 offset:20992
    ds_read_b32 v30, v5 offset:228
    s_waitcnt lgkmcnt(0)
    v_readfirstlane_b32 s59, v30
    s_xor_b32 s63, s63, s59
    s_xor_b32 s64, s64, s59
    v_mov_b32 v28, 1
    v_mov_b32 v29, 2
    s_mov_b32 s54, 0
L_lw_11:
    ds_read_b32 v8, v5 offset:32
    s_add_u32 s54, s54, 1
    s_waitcnt lgkmcnt(0)
    v_readfirstlane_b32 s53, v8
    s_cmp_gt_u32 s54, 1048576
    s_cbranch_scc1 L_lwd_12
    s_cmp_ge_u32 s53, 8
    s_cbranch_scc1 L_lwd_12
    s_branch L_lw_11
L_lwd_12:
    s_mov_b32 s54, 0
    buffer_load_dwordx4 v[48:51], v6, s[12:15], s62 offen sc1
    buffer_load_dwordx4 v[52:55], v6, s[12:15], s62 offen offset:1024 sc1
    s_sleep 1
L_pp_13:
    buffer_load_dwordx4 v[56:59], v6, s[12:15], s62 offen sc1
    buffer_load_dwordx4 v[60:63], v6, s[12:15], s62 offen offset:1024 sc1
    s_waitcnt vmcnt(2)
    v_max3_u32 v16, v48, v49, v50
    v_max3_u32 v16, v16, v51, v52
    v_max3_u32 v16, v16, v53, v54
    v_max_u32 v16, v16, v55
    v_cmp_eq_u32 vcc, -1, v16
    v_add_f32 v8, v48, v52
    v_add_f32 v9, v49, v53
    v_add_f32 v10, v50, v54
    v_add_f32 v11, v51, v55
    s_cbranch_vccz L_ppd_14
    s_sleep 1
    buffer_load_dwordx4 v[48:51], v6, s[12:15], s62 offen sc1
    buffer_load_dwordx4 v[52:55], v6, s[12:15], s62 offen offset:1024 sc1
    s_waitcnt vmcnt(2)
    v_max3_u32 v16, v56, v57, v58
    v_max3_u32 v16, v16, v59, v60
    v_max3_u32 v16, v16, v61, v62
    v_max_u32 v16, v16, v63
    v_cmp_eq_u32 vcc, -1, v16
    v_add_f32 v8, v56, v60
    v_add_f32 v9, v57, v61
    v_add_f32 v10, v58, v62
    v_add_f32 v11, v59, v63
    s_cbranch_vccz L_ppd_14
    s_sleep 1
    s_add_u32 s54, s54, 1
    s_cmp_le_u32 s54, 262144
    s_cbranch_scc1 L_pp_13
L_ppd_14:
    s_nop 0
    v_permlane32_swap_b32 v8, v9
    v_permlane32_swap_b32 v10, v11
    v_add_f32 v8, v8, v9
    v_add_f32 v10, v10, v11
    s_nop 1
    v_permlane16_swap_b32 v8, v10
    v_add_f32 v8, v8, v10
    s_nop 1
    v_add_f32_dpp v8, v8, v8 row_ror:8 row_mask:0xf bank_mask:0xf
    s_nop 1
    v_add_f32_dpp v8, v8, v8 row_ror:4 row_mask:0xf bank_mask:0xf
    v_cvt_pk_bf16_f32 v8, v8, v8
    s_mov_b64 exec, s[50:51]
    s_cmp_eq_u32 s6, 1
    s_cbranch_scc0 L_slow_15
    buffer_store_short v8, v21, s[12:15], s61 offen offset:0
L_back_16:
    s_mov_b64 exec, -1
    ds_write_b32 v5, v28 offset:4
    s_mov_b32 s54, 0
L_lw_17:
    ds_read_b32 v8, v5 offset:44
    s_add_u32 s54, s54, 1
    s_waitcnt lgkmcnt(0)
    v_readfirstlane_b32 s53, v8
    s_cmp_gt_u32 s54, 1048576
    s_cbranch_scc1 L_lwd_18
    s_cmp_ge_u32 s53, 8
    s_cbranch_scc1 L_lwd_18
    s_branch L_lw_17
L_lwd_18:
    s_waitcnt vmcnt(0)
    s_mov_b32 s54, 0
    buffer_load_dwordx4 v[48:51], v6, s[12:15], s63 offen sc1
    buffer_load_dwordx4 v[52:55], v6, s[12:15], s63 offen offset:1024 sc1
    s_sleep 1
    buffer_load_dwordx4 v[56:59], v6, s[12:15], s63 offen sc1
    buffer_load_dwordx4 v[60:63], v6, s[12:15], s63 offen offset:1024 sc1
    s_sleep 1
L_pp_19:
    buffer_load_dwordx4 v[64:67], v6, s[12:15], s63 offen sc1
    buffer_load_dwordx4 v[68:71], v6, s[12:15], s63 offen offset:1024 sc1
    s_waitcnt vmcnt(4)
    v_max3_u32 v16, v48, v49, v50
    v_max3_u32 v16, v16, v51, v52
    v_max3_u32 v16, v16, v53, v54
    v_max_u32 v16, v16, v55
    v_cmp_eq_u32 vcc, -1, v16
    v_add_f32 v8, v48, v52
    v_add_f32 v9, v49, v53
    v_add_f32 v10, v50, v54
    v_add_f32 v11, v51, v55
    s_cbranch_vccz L_ppd_20
    s_sleep 1
    buffer_load_dwordx4 v[48:51], v6, s[12:15], s63 offen sc1
    buffer_load_dwordx4 v[52:55], v6, s[12:15], s63 offen offset:1024 sc1
    s_waitcnt vmcnt(4)
    v_max3_u32 v16, v56, v57, v58
    v_max3_u32 v16, v16, v59, v60
    v_max3_u32 v16, v16, v61, v62
    v_max_u32 v16, v16, v63
    v_cmp_eq_u32 vcc, -1, v16
    v_add_f32 v8, v56, v60
    v_add_f32 v9, v57, v61
    v_add_f32 v10, v58, v62
    v_add_f32 v11, v59, v63
    s_cbranch_vccz L_ppd_20
    s_sleep 1
    buffer_load_dwordx4 v[56:59], v6, s[12:15], s63 offen sc1
    buffer_load_dwordx4 v[60:63], v6, s[12:15], s63 offen offset:1024 sc1
    s_waitcnt vmcnt(4)
    v_max3_u32 v16, v64, v65, v66
    v_max3_u32 v16, v16, v67, v68
    v_max3_u32 v16, v16, v69, v70
    v_max_u32 v16, v16, v71
    v_cmp_eq_u32 vcc, -1, v16
    v_add_f32 v8, v64, v68
    v_add_f32 v9, v65, v69
    v_add_f32 v10, v66, v70
    v_add_f32 v11, v67, v71
    s_cbranch_vccz L_ppd_20
    s_sleep 1
    s_add_u32 s54, s54, 1
    s_cmp_le_u32 s54, 262144
    s_cbranch_scc1 L_pp_19
L_ppd_20:
    s_nop 0
    v_permlane32_swap_b32 v8, v9
    v_permlane32_swap_b32 v10, v11
    v_add_f32 v8, v8, v9
    v_add_f32 v10, v10, v11
    s_nop 1
    v_permlane16_swap_b32 v8, v10
    v_add_f32 v8, v8, v10
    s_nop 1
    v_add_f32_dpp v8, v8, v8 row_ror:8 row_mask:0xf bank_mask:0xf
    s_nop 1
    v_add_f32_dpp v8, v8, v8 row_ror:4 row_mask:0xf bank_mask:0xf
    v_cvt_pk_bf16_f32 v8, v8, v8
    v_and_b32 v8, 0xffff0000, v8
    v_mul_f32 v8, v24, v8
    v_cvt_pk_bf16_f32 v8, v8, v8
    v_and_b32 v8, 0xffff0000, v8
    v_add_f32 v8, v26, v8
    v_cvt_pk_bf16_f32 v8, v8, v8
    s_mov_b64 exec, s[50:51]
    s_cmp_eq_u32 s6, 1
    s_cbranch_scc0 L_slow_21
    buffer_store_short v8, v22, s[12:15], s61 offen offset:1024
L_back_22:
    s_mov_b64 exec, -1
    ds_write_b32 v5, v29 offset:4
    v_and_b32 v26, 0xffff0000, v8
    s_cmp_lg_u32 s45, s4
    s_cbranch_scc1 L_rend
    s_mov_b32 s54, 0
L_lw_23:
    ds_read_b32 v8, v5 offset:44
    s_add_u32 s54, s54, 1
    s_waitcnt lgkmcnt(0)
    v_readfirstlane_b32 s53, v8
    s_cmp_gt_u32 s54, 1048576
    s_cbranch_scc1 L_lwd_24
    s_cmp_ge_u32 s53, 12
    s_cbranch_scc1 L_lwd_24
    s_branch L_lw_23
L_lwd_24:
    s_waitcnt vmcnt(0)
    s_mov_b32 s54, 0
    buffer_load_dwordx4 v[48:51], v6, s[12:15], s64 offen sc1
    buffer_load_dwordx4 v[52:55], v6, s[12:15], s64 offen offset:1024 sc1
    s_sleep 1
    buffer_load_dwordx4 v[56:59], v6, s[12:15], s64 offen sc1
    buffer_load_dwordx4 v[60:63], v6, s[12:15], s64 offen offset:1024 sc1
    s_sleep 1
L_pp_25:
    buffer_load_dwordx4 v[64:67], v6, s[12:15], s64 offen sc1
    buffer_load_dwordx4 v[68:71], v6, s[12:15], s64 offen offset:1024 sc1
    s_waitcnt vmcnt(4)
    v_max3_u32 v16, v48, v49, v50
    v_max3_u32 v16, v16, v51, v52
    v_max3_u32 v16, v16, v53, v54
    v_max_u32 v16, v16, v55
    v_cmp_eq_u32 vcc, -1, v16
    v_add_f32 v8, v48, v52
    v_add_f32 v9, v49, v53
    v_add_f32 v10, v50, v54
    v_add_f32 v11, v51, v55
    s_cbranch_vccz L_ppd_26
    s_sleep 1
    buffer_load_dwordx4 v[48:51], v6, s[12:15], s64 offen sc1
    buffer_load_dwordx4 v[52:55], v6, s[12:15], s64 offen offset:1024 sc1
    s_waitcnt vmcnt(4)
    v_max3_u32 v16, v56, v57, v58
    v_max3_u32 v16, v16, v59, v60
    v_max3_u32 v16, v16, v61, v62
    v_max_u32 v16, v16, v63
    v_cmp_eq_u32 vcc, -1, v16
    v_add_f32 v8, v56, v60
    v_add_f32 v9, v57, v61
    v_add_f32 v10, v58, v62
    v_add_f32 v11, v59, v63
    s_cbranch_vccz L_ppd_26
    s_sleep 1
    buffer_load_dwordx4 v[56:59], v6, s[12:15], s64 offen sc1
    buffer_load_dwordx4 v[60:63], v6, s[12:15], s64 offen offset:1024 sc1
    s_waitcnt vmcnt(4)
    v_max3_u32 v16, v64, v65, v66
    v_max3_u32 v16, v16, v67, v68
    v_max3_u32 v16, v16, v69, v70
    v_max_u32 v16, v16, v71
    v_cmp_eq_u32 vcc, -1, v16
    v_add_f32 v8, v64, v68
    v_add_f32 v9, v65, v69
    v_add_f32 v10, v66, v70
    v_add_f32 v11, v67, v71
    s_cbranch_vccz L_ppd_26
    s_sleep 1
    s_add_u32 s54, s54, 1
    s_cmp_le_u32 s54, 262144
    s_cbranch_scc1 L_pp_25
L_ppd_26:
    s_nop 0
    v_permlane32_swap_b32 v8, v9
    v_permlane32_swap_b32 v10, v11
    v_add_f32 v8, v8, v9
    v_add_f32 v10, v10, v11
    s_nop 1
    v_permlane16_swap_b32 v8, v10
    v_add_f32 v8, v8, v10
    s_nop 1
    v_add_f32_dpp v8, v8, v8 row_ror:8 row_mask:0xf bank_mask:0xf
    s_nop 1
    v_add_f32_dpp v8, v8, v8 row_ror:4 row_mask:0xf bank_mask:0xf
    v_cvt_pk_bf16_f32 v8, v8, v8
    v_and_b32 v8, 0xffff0000, v8
    v_mul_f32 v8, v25, v8
    v_cvt_pk_bf16_f32 v8, v8, v8
    v_and_b32 v8, 0xffff0000, v8
    v_add_f32 v8, v26, v8
    v_cvt_pk_bf16_f32 v8, v8, v8
    s_mov_b64 exec, s[50:51]
    buffer_store_short v8, v22, s[8:11], 0 offen
    s_mov_b64 exec, -1
    s_cmp_lg_u32 s2, 0
    s_cbranch_scc1 L_rend
    s_mov_b64 exec, 1
    buffer_store_dword v27, v5, s[12:15], 0 offen
    s_mov_b64 exec, -1
L_rend:
    s_endpgm
L_h2:
    v_lshlrev_b32 v58, 10, v2
    v_lshl_add_u32 v58, v3, 7, v58
    v_lshl_add_u32 v58, v4, 3, v58
    s_lshl_b32 s59, s3, 5
    v_add_u32 v58, s59, v58
    v_lshlrev_b32 v112, 4, v2
    s_lshl_b32 s59, s3, 8
    s_add_u32 s59, s59, 1536
    v_add_u32 v116, s59, v7
    v_add_u32 v117, s59, v112
    s_mov_b32 s68, 0x00010001
    s_mov_b32 s69, 0x00010001
    s_waitcnt lgkmcnt(0)
    s_mul_i32 s7, s7, 0x9e3779b1
    s_add_u32 s7, s7, 0x7f4a7c15
    s_cmp_ge_u32 s65, 192
    s_cbranch_scc1 L_h_nomod2
    s_waitcnt vmcnt(6)
    v_lshlrev_b32 v13, 16, v12
    v_and_b32 v14, 0xffff0000, v12
    v_mul_f32 v15, 0xbfb8aa3b, v13
    v_mul_f32 v16, 0xbfb8aa3b, v14
    v_exp_f32 v15, v15
    v_exp_f32 v16, v16
    s_nop 0
    v_add_f32 v15, 1.0, v15
    v_add_f32 v16, 1.0, v16
    v_rcp_f32 v17, v15
    v_rcp_f32 v18, v16
    s_nop 0
    v_mul_f32 v19, v13, v17
    v_mul_f32 v20, v14, v18
    v_fma_f32 v21, -v19, v15, v13
    v_fma_f32 v22, -v20, v16, v14
    v_fma_f32 v21, v21, v17, v19
    v_fma_f32 v22, v22, v18, v20
    v_cmp_o_f32 vcc, v21, v21
    s_nop 1
    v_cndmask_b32 v21, v19, v21, vcc
    v_cmp_o_f32 vcc, v22, v22
    s_nop 1
    v_cndmask_b32 v22, v20, v22, vcc
    v_cvt_pk_bf16_f32 v13, v21, v22
    ds_write_b32 v116, v13
    s_waitcnt vmcnt(2)
    v_mov_b32 v13, 1
    s_mov_b64 exec, 1
    ds_add_u32 v5, v13 offset:40
    s_mov_b64 exec, -1
    s_add_u32 s63, s62, 47104
    s_mov_b32 m0, s63
    s_nop 0
    buffer_load_dwordx4 v11, s[8:11], s60 offen nt lds
    s_add_u32 s60, s60, 0x10000
    s_add_u32 s63, s63, 1024
    s_mov_b32 m0, s63
    s_nop 0
    buffer_load_dwordx4 v11, s[8:11], s60 offen nt lds
    s_add_u32 s60, s60, 0x10000
    s_add_u32 s63, s63, 1024
    s_mov_b32 m0, s63
    s_nop 0
    buffer_load_dwordx4 v11, s[8:11], s60 offen nt lds
    s_add_u32 s60, s60, 0x10000
    s_add_u32 s63, s63, 1024
    s_mov_b32 m0, s63
    s_nop 0
    buffer_load_dwordx4 v11, s[8:11], s60 offen nt lds
    s_add_u32 s60, s60, 0x10000
    s_add_u32 s63, s63, 1024
    s_mov_b32 s54, 0
L_lw_43:
    ds_read_b32 v13, v5 offset:40
    s_add_u32 s54, s54, 1
    s_waitcnt lgkmcnt(0)
    v_readfirstlane_b32 s53, v13
    s_cmp_gt_u32 s54, 1048576
    s_cbranch_scc1 L_lwd_44
    s_cmp_ge_u32 s53, 4
    s_cbranch_scc1 L_lwd_44
    s_branch L_lw_43
L_lwd_44:
    v_add_u32 v59, 30720, v58
    ds_read_b64_tr_b16 v[64:65], v59 offset:0
    ds_read_b64_tr_b16 v[66:67], v59 offset:512
    ds_read_b64_tr_b16 v[68:69], v59 offset:4096
    ds_read_b64_tr_b16 v[70:71], v59 offset:4608
    ds_read_b64_tr_b16 v[72:73], v59 offset:8192
    ds_read_b64_tr_b16 v[74:75], v59 offset:8704
    ds_read_b64_tr_b16 v[76:77], v59 offset:12288
    ds_read_b64_tr_b16 v[78:79], v59 offset:12800
    ds_read_b128 v[24:27], v117 offset:0
    ds_read_b128 v[28:31], v117 offset:64
    ds_read_b128 v[32:35], v117 offset:128
    ds_read_b128 v[36:39], v117 offset:192
    s_waitcnt lgkmcnt(0)
    v_mfma_f32_16x16x32_bf16 v[8:11], v[64:67], v[24:27], 0
    v_mfma_f32_16x16x32_bf16 v[8:11], v[68:71], v[28:31], v[8:11]
    v_mfma_f32_16x16x32_bf16 v[8:11], v[72:75], v[32:35], v[8:11]
    v_mfma_f32_16x16x32_bf16 v[8:11], v[76:79], v[36:39], v[8:11]
    s_mul_i32 s59, s47, 24576
    s_lshl_b32 s60, s46, 9
    s_add_u32 s59, s59, s60
    s_lshl_b32 s60, s3, 7
    s_add_u32 s59, s59, s60
    s_add_u32 s59, s59, 16384
    v_add_u32 v20, v116, v7
    v_mov_b32 v17, s7
    v_mov_b32 v19, s7
    s_mov_b64 exec, s[68:69]
    ds_write_b128 v117, v[8:11]
    s_mov_b64 exec, 0xff
    ds_read_b64 v[12:13], v20
    s_mov_b64 exec, -1
    s_waitcnt lgkmcnt(0)
    v_mov_b32 v16, v12
    v_mov_b32 v18, v13
    s_mov_b64 exec, 0xff
    buffer_store_dwordx4 v[16:19], v6, s[12:15], s59 offen sc1
    s_mov_b64 exec, -1
    s_waitcnt vmcnt(1)
    s_branch L_h_wq_ok
L_h_nomod2:
    s_add_u32 s63, s62, 47104
    s_mov_b32 m0, s63
    s_nop 0
    buffer_load_dwordx4 v11, s[8:11], s60 offen nt lds
    s_add_u32 s60, s60, 0x10000
    s_add_u32 s63, s63, 1024
    s_mov_b32 m0, s63
    s_nop 0
    buffer_load_dwordx4 v11, s[8:11], s60 offen nt lds
    s_add_u32 s60, s60, 0x10000
    s_add_u32 s63, s63, 1024
    s_mov_b32 m0, s63
    s_nop 0
    buffer_load_dwordx4 v11, s[8:11], s60 offen nt lds
    s_add_u32 s60, s60, 0x10000
    s_add_u32 s63, s63, 1024
    s_mov_b32 m0, s63
    s_nop 0
    buffer_load_dwordx4 v11, s[8:11], s60 offen nt lds
    s_add_u32 s60, s60, 0x10000
    s_add_u32 s63, s63, 1024
    s_waitcnt vmcnt(0)
L_h_wq_ok:
    v_mov_b32 v13, 1
    s_mov_b64 exec, 1
    ds_add_u32 v5, v13 offset:44
    s_mov_b64 exec, -1
    s_lshl_b32 s63, s44, 10
    s_cmp_lg_u32 s3, 0
    s_cbranch_scc1 L_h_waith
    v_lshlrev_b32 v20, 16, v152
    v_and_b32 v21, 0xffff0000, v152
    v_lshlrev_b32 v22, 16, v153
    v_and_b32 v23, 0xffff0000, v153
    v_lshlrev_b32 v24, 16, v154
    v_and_b32 v25, 0xffff0000, v154
    v_lshlrev_b32 v26, 16, v155
    v_and_b32 v27, 0xffff0000, v155
    v_readfirstlane_b32 s55, v20
    s_nop 1
    v_sub_f32 v28, 0, s55
    v_sub_f32 v29, 0, s55
    v_pk_add_f32 v[20:21], v[20:21], v[28:29]
    v_pk_add_f32 v[22:23], v[22:23], v[28:29]
    v_pk_add_f32 v[24:25], v[24:25], v[28:29]
    v_pk_add_f32 v[26:27], v[26:27], v[28:29]
    v_pk_mul_f32 v[30:31], v[20:21], v[20:21]
    v_pk_add_f32 v[28:29], v[20:21], v[22:23]
    v_pk_fma_f32 v[30:31], v[22:23], v[22:23], v[30:31]
    v_pk_fma_f32 v[30:31], v[24:25], v[24:25], v[30:31]
    v_pk_add_f32 v[28:29], v[28:29], v[24:25]
    v_pk_fma_f32 v[30:31], v[26:27], v[26:27], v[30:31]
    v_pk_add_f32 v[28:29], v[28:29], v[26:27]
    v_add_f32 v31, v30, v31
    v_add_f32 v30, v28, v29
    s_nop 1
    v_permlane32_swap_b32 v30, v31
    v_add_f32 v30, v30, v31
    v_mov_b32 v31, v30
    s_nop 1
    v_permlane16_swap_b32 v30, v31
    v_add_f32 v30, v30, v31
    s_nop 1
    v_add_f32_dpp v30, v30, v30 row_ror:8 row_mask:0xf bank_mask:0xf
    s_nop 1
    v_add_f32_dpp v30, v30, v30 row_ror:4 row_mask:0xf bank_mask:0xf
    s_nop 1
    v_add_f32_dpp v30, v30, v30 row_ror:2 row_mask:0xf bank_mask:0xf
    s_nop 1
    v_add_f32_dpp v30, v30, v30 row_ror:1 row_mask:0xf bank_mask:0xf
    v_mul_f32 v30, 0x3b000000, v30
    s_nop 0
    v_readlane_b32 s56, v30, 0
    v_readlane_b32 s57, v30, 32
    s_nop 0
    v_mov_b32 v31, s56
    v_fma_f32 v30, -v31, v31, s57
    v_add_f32 v31, s55, v31
    v_cvt_pk_bf16_f32 v28, v30, v31
    v_lshlrev_b32 v30, 16, v28
    v_and_b32 v28, 0xffff0000, v28
    v_max_f32 v30, 0, v30
    v_add_f32 v30, 0x3727c5ac, v30
    v_cvt_pk_bf16_f32 v30, v30, v30
    v_and_b32 v30, 0xffff0000, v30
    v_sqrt_f32 v30, v30
    s_nop 0
    v_cvt_pk_bf16_f32 v30, v30, v30
    v_and_b32 v30, 0xffff0000, v30
    v_rcp_f32 v29, v30
    s_nop 0
    s_sleep 30
    s_mov_b32 s54, 0
L_poll_45:
    s_sleep 4
    s_mov_b32 s59, 16384
    s_add_u32 s59, s59, s63
    buffer_load_dwordx4 v[120:123], v6, s[12:15], s59 offen sc1
    s_mov_b32 s59, 40960
    s_add_u32 s59, s59, s63
    buffer_load_dwordx4 v[124:127], v6, s[12:15], s59 offen sc1
    s_mov_b32 s59, 65536
    s_add_u32 s59, s59, s63
    buffer_load_dwordx4 v[128:131], v6, s[12:15], s59 offen sc1
    s_mov_b32 s59, 90112
    s_add_u32 s59, s59, s63
    buffer_load_dwordx4 v[132:135], v6, s[12:15], s59 offen sc1
    s_mov_b32 s59, 20480
    s_add_u32 s59, s59, s63
    buffer_load_dwordx4 v[136:139], v6, s[12:15], s59 offen sc1
    s_mov_b32 s59, 45056
    s_add_u32 s59, s59, s63
    buffer_load_dwordx4 v[140:143], v6, s[12:15], s59 offen sc1
    s_mov_b32 s59, 69632
    s_add_u32 s59, s59, s63
    buffer_load_dwordx4 v[144:147], v6, s[12:15], s59 offen sc1
    s_mov_b32 s59, 94208
    s_add_u32 s59, s59, s63
    buffer_load_dwordx4 v[148:151], v6, s[12:15], s59 offen sc1
    s_waitcnt vmcnt(0)
    v_mov_b32 v20, 0
    v_xor_b32 v21, s7, v121
    v_or_b32 v20, v20, v21
    v_xor_b32 v21, s7, v123
    v_or_b32 v20, v20, v21
    v_xor_b32 v21, s7, v125
    v_or_b32 v20, v20, v21
    v_xor_b32 v21, s7, v127
    v_or_b32 v20, v20, v21
    v_xor_b32 v21, s7, v129
    v_or_b32 v20, v20, v21
    v_xor_b32 v21, s7, v131
    v_or_b32 v20, v20, v21
    v_xor_b32 v21, s7, v133
    v_or_b32 v20, v20, v21
    v_xor_b32 v21, s7, v135
    v_or_b32 v20, v20, v21
    v_xor_b32 v21, s7, v137
    v_or_b32 v20, v20, v21
    v_xor_b32 v21, s7, v139
    v_or_b32 v20, v20, v21
    v_xor_b32 v21, s7, v141
    v_or_b32 v20, v20, v21
    v_xor_b32 v21, s7, v143
    v_or_b32 v20, v20, v21
    v_xor_b32 v21, s7, v145
    v_or_b32 v20, v20, v21
    v_xor_b32 v21, s7, v147
    v_or_b32 v20, v20, v21
    v_xor_b32 v21, s7, v149
    v_or_b32 v20, v20, v21
    v_xor_b32 v21, s7, v151
    v_or_b32 v20, v20, v21
    v_cmp_ne_u32 vcc, 0, v20
    s_add_u32 s54, s54, 1
    s_cmp_gt_u32 s54, 262144
    s_cbranch_scc1 L_pd_46
    s_cbranch_vccnz L_poll_45
L_pd_46:
    v_add_f32 v12, v120, v124
    v_add_f32 v12, v12, v128
    v_add_f32 v12, v12, v132
    v_cvt_pk_bf16_f32 v12, v12, v12
    v_and_b32 v12, 0xffff0000, v12
    v_add_f32 v13, v122, v126
    v_add_f32 v13, v13, v130
    v_add_f32 v13, v13, v134
    v_cvt_pk_bf16_f32 v13, v13, v13
    v_and_b32 v13, 0xffff0000, v13
    v_add_f32 v14, v136, v140
    v_add_f32 v14, v14, v144
    v_add_f32 v14, v14, v148
    v_cvt_pk_bf16_f32 v14, v14, v14
    v_and_b32 v14, 0xffff0000, v14
    v_add_f32 v15, v138, v142
    v_add_f32 v15, v15, v146
    v_add_f32 v15, v15, v150
    v_cvt_pk_bf16_f32 v15, v15, v15
    v_and_b32 v15, 0xffff0000, v15
    v_add_f32 v14, 1.0, v14
    v_add_f32 v15, 1.0, v15
    v_cvt_pk_bf16_f32 v14, v14, v14
    v_and_b32 v14, 0xffff0000, v14
    v_cvt_pk_bf16_f32 v15, v15, v15
    v_and_b32 v15, 0xffff0000, v15
    v_lshlrev_b32 v20, 16, v156
    v_and_b32 v21, 0xffff0000, v156
    v_sub_f32 v20, v20, v28
    v_sub_f32 v21, v21, v28
    v_cvt_pk_bf16_f32 v22, v20, v21
    v_lshlrev_b32 v20, 16, v22
    v_and_b32 v21, 0xffff0000, v22
    v_mul_f32 v20, v29, v20
    v_mul_f32 v21, v29, v21
    v_cvt_pk_bf16_f32 v22, v20, v21
    v_lshlrev_b32 v20, 16, v22
    v_and_b32 v21, 0xffff0000, v22
    v_mul_f32 v20, v14, v20
    v_mul_f32 v21, v15, v21
    v_cvt_pk_bf16_f32 v22, v20, v21
    v_lshlrev_b32 v20, 16, v22
    v_and_b32 v21, 0xffff0000, v22
    v_add_f32 v20, v12, v20
    v_add_f32 v21, v13, v21
    v_cvt_pk_bf16_f32 v22, v20, v21
    ds_write_b32 v7, v22 offset:1280
    v_mov_b32 v13, 1
    ds_write_b32 v5, v13 offset:36
L_h_waith:
    s_mov_b32 s54, 0
L_lw_47:
    ds_read_b32 v13, v5 offset:44
    s_add_u32 s54, s54, 1
    s_waitcnt lgkmcnt(0)
    v_readfirstlane_b32 s53, v13
    s_cmp_gt_u32 s54, 1048576
    s_cbranch_scc1 L_lwd_48
    s_cmp_ge_u32 s53, 4
    s_cbranch_scc1 L_lwd_48
    s_sleep 1
    s_branch L_lw_47
L_lwd_48:
    v_add_u32 v59, 47104, v58
    ds_read_b64_tr_b16 v[64:65], v59 offset:0
    ds_read_b64_tr_b16 v[66:67], v59 offset:512
    ds_read_b64_tr_b16 v[68:69], v59 offset:4096
    ds_read_b64_tr_b16 v[70:71], v59 offset:4608
    ds_read_b64_tr_b16 v[72:73], v59 offset:8192
    ds_read_b64_tr_b16 v[74:75], v59 offset:8704
    ds_read_b64_tr_b16 v[76:77], v59 offset:12288
    ds_read_b64_tr_b16 v[78:79], v59 offset:12800
    s_mov_b32 s54, 0
L_lw_49:
    ds_read_b32 v13, v5 offset:8
    s_add_u32 s54, s54, 1
    s_waitcnt lgkmcnt(0)
    v_readfirstlane_b32 s53, v13
    s_cmp_gt_u32 s54, 1048576
    s_cbranch_scc1 L_lwd_50
    s_cmp_lg_u32 s53, 0
    s_cbranch_scc1 L_lwd_50
    s_sleep 1
    s_branch L_lw_49
L_lwd_50:
    s_mov_b32 s6, s53
    s_lshl_b32 s61, s6, 20
    s_mul_i32 s59, s4, 90112
    s_add_u32 s61, s61, s59
    s_mov_b32 s54, 0
L_lw_51:
    ds_read_b32 v13, v5 offset:36
    s_add_u32 s54, s54, 1
    s_waitcnt lgkmcnt(0)
    v_readfirstlane_b32 s53, v13
    s_cmp_gt_u32 s54, 1048576
    s_cbranch_scc1 L_lwd_52
    s_cmp_lg_u32 s53, 0
    s_cbranch_scc1 L_lwd_52
    s_sleep 1
    s_branch L_lw_51
L_lwd_52:
    ds_read_b128 v[24:27], v112 offset:1280
    ds_read_b128 v[28:31], v112 offset:1344
    ds_read_b128 v[32:35], v112 offset:1408
    ds_read_b128 v[36:39], v112 offset:1472
    s_waitcnt lgkmcnt(0)
    v_mfma_f32_16x16x32_bf16 v[8:11], v[64:67], v[24:27], 0
    v_mfma_f32_16x16x32_bf16 v[8:11], v[68:71], v[28:31], v[8:11]
    v_mfma_f32_16x16x32_bf16 v[8:11], v[72:75], v[32:35], v[8:11]
    v_mfma_f32_16x16x32_bf16 v[8:11], v[76:79], v[36:39], v[8:11]
    s_lshl_b32 s59, s45, 2
    s_add_u32 s59, s59, s3
    s_mov_b32 s46, s59
    s_lshl_b32 s59, s59, 6
    s_lshl_b32 s60, s44, 11
    s_add_u32 s47, s59, s60
    s_add_u32 s59, s47, s61
    s_add_u32 s59, s59, 8192
    s_mov_b64 exec, s[68:69]
    s_nop 1
    s_cmp_eq_u32 s6, 1
    s_cbranch_scc0 L_slow_53
    buffer_store_dwordx4 v[8:11], v112, s[12:15], s59 offen
L_back_54:
    s_mov_b64 exec, -1
    s_cmp_lg_u32 s3, 0
    s_cbranch_scc1 L_tailprep
    s_add_u32 s59, s61, 8192
    s_add_u32 s60, s59, 4096
    s_mov_b32 s54, 0
L_poll_55:
    buffer_load_dwordx4 v[120:123], v6, s[12:15], s59 offen offset:0 sc1
    buffer_load_dwordx4 v[124:127], v6, s[12:15], s59 offen offset:1024 sc1
    buffer_load_dwordx4 v[128:131], v6, s[12:15], s59 offen offset:2048 sc1
    buffer_load_dwordx4 v[132:135], v6, s[12:15], s59 offen offset:3072 sc1
    buffer_load_dwordx4 v[136:139], v6, s[12:15], s60 offen offset:0 sc1
    buffer_load_dwordx4 v[140:143], v6, s[12:15], s60 offen offset:1024 sc1
    buffer_load_dwordx4 v[144:147], v6, s[12:15], s60 offen offset:2048 sc1
    buffer_load_dwordx4 v[148:151], v6, s[12:15], s60 offen offset:3072 sc1
    s_waitcnt vmcnt(0)
    v_max3_u32 v21, v120, v121, v122
    v_max3_u32 v21, v21, v123, v124
    v_max3_u32 v21, v21, v125, v126
    v_max3_u32 v21, v21, v127, v128
    v_max3_u32 v21, v21, v129, v130
    v_max3_u32 v21, v21, v131, v132
    v_max3_u32 v21, v21, v133, v134
    v_max3_u32 v21, v21, v135, v136
    v_max3_u32 v21, v21, v137, v138
    v_max3_u32 v21, v21, v139, v140
    v_max3_u32 v21, v21, v141, v142
    v_max3_u32 v21, v21, v143, v144
    v_max3_u32 v21, v21, v145, v146
    v_max3_u32 v21, v21, v147, v148
    v_max3_u32 v21, v21, v149, v150
    v_max_u32 v21, v21, v151
    v_cmp_eq_u32 vcc, -1, v21
    s_add_u32 s54, s54, 1
    s_cmp_gt_u32 s54, 262144
    s_cbranch_scc1 L_pd_56
    s_cbranch_vccnz L_poll_55
L_pd_56:
    v_add_f32 v120, v120, v128
    v_add_f32 v120, v120, v136
    v_add_f32 v120, v120, v144
    v_add_f32 v121, v121, v129
    v_add_f32 v121, v121, v137
    v_add_f32 v121, v121, v145
    v_add_f32 v122, v122, v130
    v_add_f32 v122, v122, v138
    v_add_f32 v122, v122, v146
    v_add_f32 v123, v123, v131
    v_add_f32 v123, v123, v139
    v_add_f32 v123, v123, v147
    v_add_f32 v124, v124, v132
    v_add_f32 v124, v124, v140
    v_add_f32 v124, v124, v148
    v_add_f32 v125, v125, v133
    v_add_f32 v125, v125, v141
    v_add_f32 v125, v125, v149
    v_add_f32 v126, v126, v134
    v_add_f32 v126, v126, v142
    v_add_f32 v126, v126, v150
    v_add_f32 v127, v127, v135
    v_add_f32 v127, v127, v143
    v_add_f32 v127, v127, v151
    v_cvt_pk_bf16_f32 v8, v120, v121
    v_cvt_pk_bf16_f32 v9, v122, v123
    v_cvt_pk_bf16_f32 v10, v124, v125
    v_cvt_pk_bf16_f32 v11, v126, v127
    v_lshlrev_b32 v20, 3, v0
    ds_write_b64 v20, v[8:9] offset:256
    ds_write_b64 v20, v[10:11] offset:768
    v_mov_b32 v12, s6
    ds_write_b32 v5, v12 offset:0
L_tailprep:
    s_cmp_lg_u32 s3, 1
    s_cbranch_scc1 L_tp1
    s_mov_b32 s54, 0
L_poll_57:
    s_sleep 16
    s_mov_b32 s59, 28672
    s_add_u32 s59, s59, s63
    buffer_load_dwordx4 v[120:123], v6, s[12:15], s59 offen sc1
    s_mov_b32 s59, 53248
    s_add_u32 s59, s59, s63
    buffer_load_dwordx4 v[124:127], v6, s[12:15], s59 offen sc1
    s_mov_b32 s59, 77824
    s_add_u32 s59, s59, s63
    buffer_load_dwordx4 v[128:131], v6, s[12:15], s59 offen sc1
    s_mov_b32 s59, 102400
    s_add_u32 s59, s59, s63
    buffer_load_dwordx4 v[132:135], v6, s[12:15], s59 offen sc1
    s_mov_b32 s59, 32768
    s_add_u32 s59, s59, s63
    buffer_load_dwordx4 v[136:139], v6, s[12:15], s59 offen sc1
    s_mov_b32 s59, 57344
    s_add_u32 s59, s59, s63
    buffer_load_dwordx4 v[140:143], v6, s[12:15], s59 offen sc1
    s_mov_b32 s59, 81920
    s_add_u32 s59, s59, s63
    buffer_load_dwordx4 v[144:147], v6, s[12:15], s59 offen sc1
    s_mov_b32 s59, 106496
    s_add_u32 s59, s59, s63
    buffer_load_dwordx4 v[148:151], v6, s[12:15], s59 offen sc1
    s_waitcnt vmcnt(0)
    v_mov_b32 v20, 0
    v_xor_b32 v21, s7, v121
    v_or_b32 v20, v20, v21
    v_xor_b32 v21, s7, v123
    v_or_b32 v20, v20, v21
    v_xor_b32 v21, s7, v125
    v_or_b32 v20, v20, v21
    v_xor_b32 v21, s7, v127
    v_or_b32 v20, v20, v21
    v_xor_b32 v21, s7, v129
    v_or_b32 v20, v20, v21
    v_xor_b32 v21, s7, v131
    v_or_b32 v20, v20, v21
    v_xor_b32 v21, s7, v133
    v_or_b32 v20, v20, v21
    v_xor_b32 v21, s7, v135
    v_or_b32 v20, v20, v21
    v_xor_b32 v21, s7, v137
    v_or_b32 v20, v20, v21
    v_xor_b32 v21, s7, v139
    v_or_b32 v20, v20, v21
    v_xor_b32 v21, s7, v141
    v_or_b32 v20, v20, v21
    v_xor_b32 v21, s7, v143
    v_or_b32 v20, v20, v21
    v_xor_b32 v21, s7, v145
    v_or_b32 v20, v20, v21
    v_xor_b32 v21, s7, v147
    v_or_b32 v20, v20, v21
    v_xor_b32 v21, s7, v149
    v_or_b32 v20, v20, v21
    v_xor_b32 v21, s7, v151
    v_or_b32 v20, v20, v21
    v_cmp_ne_u32 vcc, 0, v20
    s_add_u32 s54, s54, 1
    s_cmp_gt_u32 s54, 262144
    s_cbranch_scc1 L_pd_58
    s_cbranch_vccnz L_poll_57
L_pd_58:
    v_add_f32 v108, v120, v124
    v_add_f32 v108, v108, v128
    v_add_f32 v108, v108, v132
    v_cvt_pk_bf16_f32 v108, v108, v108
    v_and_b32 v108, 0xffff0000, v108
    v_add_f32 v109, v122, v126
    v_add_f32 v109, v109, v130
    v_add_f32 v109, v109, v134
    v_cvt_pk_bf16_f32 v109, v109, v109
    v_and_b32 v109, 0xffff0000, v109
    v_add_f32 v110, v136, v140
    v_add_f32 v110, v110, v144
    v_add_f32 v110, v110, v148
    v_cvt_pk_bf16_f32 v110, v110, v110
    v_and_b32 v110, 0xffff0000, v110
    v_add_f32 v111, v138, v142
    v_add_f32 v111, v111, v146
    v_add_f32 v111, v111, v150
    v_cvt_pk_bf16_f32 v111, v111, v111
    v_and_b32 v111, 0xffff0000, v111
    v_add_f32 v110, 1.0, v110
    v_add_f32 v111, 1.0, v111
    v_cvt_pk_bf16_f32 v110, v110, v110
    v_and_b32 v110, 0xffff0000, v110
    v_cvt_pk_bf16_f32 v111, v111, v111
    v_and_b32 v111, 0xffff0000, v111
    ds_write_b128 v6, v[108:111] offset:19968
    v_mov_b32 v13, 1
    s_mov_b64 exec, 1
    ds_add_u32 v5, v13 offset:60
    s_mov_b64 exec, -1
L_tp1:
    s_cmp_lg_u32 s3, 2
    s_cbranch_scc1 L_tp2
    v_and_b32 v20, 1, v2
    v_lshlrev_b32 v20, 1, v20
    v_lshrrev_b32 v21, 1, v2
    v_or_b32 v20, v20, v21
    v_add_u32 v20, s4, v20
    v_and_b32 v20, 3, v20
    v_lshl_add_u32 v20, v20, 2, v4
    s_lshl_b32 s59, s5, 4
    v_add_u32 v20, s59, v20
    v_lshlrev_b32 v23, 1, v20
    v_lshlrev_b32 v22, 3, v20
    buffer_load_ushort v106, v23, s[48:51], 0 offen
    s_mov_b32 s62, 0
    s_mov_b32 s54, 0
L_poll_59:
    s_sleep 16
    s_mov_b32 s59, 24576
    s_add_u32 s59, s59, s62
    buffer_load_dwordx2 v[120:121], v22, s[12:15], s59 offen sc1
    s_mov_b32 s59, 49152
    s_add_u32 s59, s59, s62
    buffer_load_dwordx2 v[122:123], v22, s[12:15], s59 offen sc1
    s_mov_b32 s59, 73728
    s_add_u32 s59, s59, s62
    buffer_load_dwordx2 v[124:125], v22, s[12:15], s59 offen sc1
    s_mov_b32 s59, 98304
    s_add_u32 s59, s59, s62
    buffer_load_dwordx2 v[126:127], v22, s[12:15], s59 offen sc1
    s_mov_b32 s59, 36864
    s_add_u32 s59, s59, s62
    buffer_load_dwordx2 v[128:129], v22, s[12:15], s59 offen sc1
    s_mov_b32 s59, 61440
    s_add_u32 s59, s59, s62
    buffer_load_dwordx2 v[130:131], v22, s[12:15], s59 offen sc1
    s_mov_b32 s59, 86016
    s_add_u32 s59, s59, s62
    buffer_load_dwordx2 v[132:133], v22, s[12:15], s59 offen sc1
    s_mov_b32 s59, 110592
    s_add_u32 s59, s59, s62
    buffer_load_dwordx2 v[134:135], v22, s[12:15], s59 offen sc1
    s_waitcnt vmcnt(0)
    v_mov_b32 v20, 0
    v_xor_b32 v21, s7, v121
    v_or_b32 v20, v20, v21
    v_xor_b32 v21, s7, v123
    v_or_b32 v20, v20, v21
    v_xor_b32 v21, s7, v125
    v_or_b32 v20, v20, v21
    v_xor_b32 v21, s7, v127
    v_or_b32 v20, v20, v21
    v_xor_b32 v21, s7, v129
    v_or_b32 v20, v20, v21
    v_xor_b32 v21, s7, v131
    v_or_b32 v20, v20, v21
    v_xor_b32 v21, s7, v133
    v_or_b32 v20, v20, v21
    v_xor_b32 v21, s7, v135
    v_or_b32 v20, v20, v21
    v_cmp_ne_u32 vcc, 0, v20
    s_add_u32 s54, s54, 1
    s_cmp_gt_u32 s54, 262144
    s_cbranch_scc1 L_pd_60
    s_cbranch_vccnz L_poll_59
L_pd_60:
    v_add_f32 v104, v120, v122
    v_add_f32 v104, v104, v124
    v_add_f32 v104, v104, v126
    v_cvt_pk_bf16_f32 v104, v104, v104
    v_and_b32 v104, 0xffff0000, v104
    v_add_f32 v105, v128, v130
    v_add_f32 v105, v105, v132
    v_add_f32 v105, v105, v134
    v_cvt_pk_bf16_f32 v105, v105, v105
    v_and_b32 v105, 0xffff0000, v105
    v_lshlrev_b32 v106, 16, v106
    v_mov_b32 v107, s7
    ds_write_b128 v6, v[104:107] offset:20992
    v_mov_b32 v13, 1
    s_mov_b64 exec, 1
    ds_add_u32 v5, v13 offset:60
    s_mov_b64 exec, -1
L_tp2:
    s_cmp_lg_u32 s3, 3
    s_cbranch_scc1 L_tp3
    s_mov_b64 exec, 0xf
    s_mov_b32 s54, 0
L_poll_61:
    s_sleep 32
    buffer_load_dwordx4 v[8:11], v6, s[12:15], 0 offen offset:2048 sc1
    s_waitcnt vmcnt(0)
    v_xor_b32 v9, s7, v9
    v_xor_b32 v11, s7, v11
    v_or_b32 v9, v9, v11
    v_cmp_ne_u32 vcc, 0, v9
    s_add_u32 s54, s54, 1
    s_cmp_gt_u32 s54, 262144
    s_cbranch_scc1 L_pd_62
    s_cbranch_vccnz L_poll_61
L_pd_62:
    s_mov_b64 exec, 1
    v_and_b32 v8, 1, v8
    v_lshlrev_b32 v8, 13, v8
    ds_write_b32 v5, v8 offset:228
    s_mov_b64 exec, -1
    v_mov_b32 v13, 1
    s_mov_b64 exec, 1
    ds_add_u32 v5, v13 offset:60
    s_mov_b64 exec, -1
L_tp3:
    s_mov_b32 s54, 0
L_lw_63:
    ds_read_b32 v13, v5 offset:60
    s_add_u32 s54, s54, 1
    s_waitcnt lgkmcnt(0)
    v_readfirstlane_b32 s53, v13
    s_cmp_gt_u32 s54, 1048576
    s_cbranch_scc1 L_lwd_64
    s_cmp_ge_u32 s53, 3
    s_cbranch_scc1 L_lwd_64
    s_sleep 4
    s_branch L_lw_63
L_lwd_64:
    ds_read_b128 v[108:111], v6 offset:19968
    ds_read_b32 v122, v5 offset:228
    s_mov_b32 s54, 0
L_lw_65:
    ds_read_b32 v13, v5 offset:48
    s_add_u32 s54, s54, 1
    s_waitcnt lgkmcnt(0)
    v_readfirstlane_b32 s53, v13
    s_cmp_gt_u32 s54, 1048576
    s_cbranch_scc1 L_lwd_66
    s_cmp_ge_u32 s53, 4
    s_cbranch_scc1 L_lwd_66
    s_sleep 4
    s_branch L_lw_65
L_lwd_66:
    v_add_u32 v59, 63488, v58
    ds_read_b64_tr_b16 v[64:65], v59 offset:0
    ds_read_b64_tr_b16 v[66:67], v59 offset:512
    ds_read_b64_tr_b16 v[68:69], v59 offset:4096
    ds_read_b64_tr_b16 v[70:71], v59 offset:4608
    ds_read_b64_tr_b16 v[72:73], v59 offset:8192
    ds_read_b64_tr_b16 v[74:75], v59 offset:8704
    ds_read_b64_tr_b16 v[76:77], v59 offset:12288
    ds_read_b64_tr_b16 v[78:79], v59 offset:12800
    v_add_u32 v113, s67, v112
    v_add_u32 v114, s67, v7
    s_lshr_b32 s56, s4, 1
    s_mul_i32 s56, s56, 448
    s_and_b32 s57, s4, 1
    s_lshl_b32 s59, s57, 8
    s_add_u32 s56, s56, s59
    s_sub_u32 s57, 4, s57
    s_mov_b32 s52, s57
    s_lshl_b32 s62, s44, 3
    s_add_u32 s62, s62, s4
    s_lshl_b32 s62, s62, 6
    s_lshl_b32 s63, s46, 14
    s_add_u32 s64, s62, s63
    s_add_u32 s64, s64, 262144
    s_lshl_b32 s63, s46, 11
    s_add_u32 s65, s62, s63
    s_add_u32 s65, s65, 131072
    v_lshlrev_b32 v118, 4, v4
    v_lshrrev_b32 v115, 2, v0
    v_lshl_add_u32 v115, v115, 11, v118
    s_lshl_b32 s59, s3, 2
    s_lshl_b64 s[26:27], 0xf, s59
    v_readfirstlane_b32 s59, v122
    v_xor_b32 v115, v115, v122
    s_xor_b32 s65, s65, s59
    s_add_u32 s47, s47, s61
    s_add_u32 s47, s47, 16384
    s_add_u32 s62, s61, 16384
    s_add_u32 s63, s62, 4096
    v_lshlrev_b32 v119, 1, v0
    s_lshl_b32 s59, s3, 8
    s_add_u32 s59, s59, 1536
    v_add_u32 v119, s59, v119
    s_waitcnt lgkmcnt(0)
    v_lshrrev_b32 v24, 3, v0
    v_and_b32 v25, 7, v0
    v_lshlrev_b32 v25, 4, v25
    v_lshl_add_u32 v26, v24, 10, v25
    s_movk_i32 s59, 3584
    v_mad_u32_u24 v27, v24, s59, v25
    s_mov_b32 s48, s32
    s_mov_b32 s49, s33
    s_mov_b32 s50, 0x1c0000
    s_mov_b32 s51, 0x20000
    s_cmp_lt_u32 s45, 4
    s_cselect_b32 s8, s28, s30
    s_cselect_b32 s9, s29, s31
    s_mov_b32 s10, 0x1c0000
    s_mov_b32 s11, 0x20000
    s_lshl_b32 s59, s5, 8
    s_add_u32 s59, s59, 16384
    v_add_u32 v28, s59, v6
    s_lshl_b32 s59, s5, 6
    s_sub_u32 s59, s59, 256
    v_add_u32 v29, s59, v6
    v_cmp_gt_u32 vcc, 16, v0
    s_lshl_b32 s59, s5, 11
    s_lshl_b32 s60, s3, 10
    s_add_u32 s59, s59, s60
    s_add_u32 s59, s59, 24576
    v_cndmask_b32 v28, v29, v28, vcc
    v_add_u32 v29, s59, v6
    v_mov_b32 v120, v26
    v_mov_b32 v121, v27
    s_mov_b32 s66, s56
    s_mov_b32 s54, 0
L_lw_67:
    ds_read_b32 v8, v5 offset:12
    s_add_u32 s54, s54, 1
    s_waitcnt lgkmcnt(0)
    v_readfirstlane_b32 s53, v8
    s_cmp_gt_u32 s54, 1048576
    s_cbranch_scc1 L_lwd_68
    s_cmp_ge_u32 s53, 20
    s_cbranch_scc1 L_lwd_68
    s_sleep 2
    s_branch L_lw_67
L_lwd_68:
    s_cmp_gt_u32 s3, 2
    s_cbranch_scc1 L_w_done
    s_cmp_eq_u32 s3, 2
    s_cbranch_scc1 L_w_sh
    buffer_load_dwordx4 v[32:35], v29, s[12:15], s61 offen sc1
    s_branch L_w_done
L_w_sh:
    s_mov_b64 exec, 0xfffff
    buffer_load_dwordx4 v[32:35], v28, s[12:15], s61 offen sc1
    s_mov_b64 exec, -1
L_w_done:
    s_and_b32 s60, s45, 3
    s_cmp_ge_u32 s60, s52
    s_cbranch_scc1 L_t_nogu
    s_lshl_b32 s60, s60, 6
    s_add_u32 s60, s60, s66
    s_lshl_b32 s60, s60, 1
    s_lshl_b32 s59, s44, 2
    s_add_u32 s59, s59, s3
    s_mul_i32 s59, s59, 114688
    s_add_u32 s59, s59, s60
    s_lshl_b32 s60, s3, 12
    s_add_u32 s60, s60, 79872
    s_mov_b32 m0, s60
    s_nop 0
    buffer_load_dwordx4 v121, s[8:11], s59 offen nt lds
    s_add_u32 s59, s59, 28672
    s_add_u32 s60, s60, 1024
    s_mov_b32 m0, s60
    s_nop 0
    buffer_load_dwordx4 v121, s[8:11], s59 offen nt lds
    s_add_u32 s59, s59, 28672
    s_add_u32 s60, s60, 1024
    s_mov_b32 m0, s60
    s_nop 0
    buffer_load_dwordx4 v121, s[8:11], s59 offen nt lds
    s_add_u32 s59, s59, 28672
    s_add_u32 s60, s60, 1024
    s_mov_b32 m0, s60
    s_nop 0
    buffer_load_dwordx4 v121, s[8:11], s59 offen nt lds
    s_add_u32 s59, s59, 28672
    s_add_u32 s60, s60, 1024
L_t_nogu:
    s_cmp_ge_u32 s44, s52
    s_cbranch_scc1 L_t_nodn
    s_lshl_b32 s59, s44, 6
    s_add_u32 s59, s59, s66
    s_lshl_b32 s60, s3, 4
    s_add_u32 s59, s59, s60
    s_lshl_b32 s59, s59, 10
    s_lshl_b32 s60, s45, 7
    s_add_u32 s59, s59, s60
    s_lshl_b32 s60, s3, 11
    s_add_u32 s60, s60, 22528
    s_mov_b32 m0, s60
    s_nop 0
    buffer_load_dwordx4 v120, s[48:51], s59 offen nt lds
    s_add_u32 s59, s59, 8192
    s_add_u32 s60, s60, 1024
    s_mov_b32 m0, s60
    s_nop 0
    buffer_load_dwordx4 v120, s[48:51], s59 offen nt lds
    s_add_u32 s59, s59, 8192
    s_add_u32 s60, s60, 1024
L_t_nodn:
    s_waitcnt vmcnt(0)
    v_mov_b32 v8, 1
    s_mov_b64 exec, 1
    ds_add_u32 v5, v8 offset:48
    s_mov_b64 exec, -1
    s_mov_b32 s54, 0
L_lw_69:
    ds_read_b32 v8, v5 offset:32
    s_add_u32 s54, s54, 1
    s_waitcnt lgkmcnt(0)
    v_readfirstlane_b32 s53, v8
    s_cmp_gt_u32 s54, 1048576
    s_cbranch_scc1 L_lwd_70
    s_cmp_ge_u32 s53, 8
    s_cbranch_scc1 L_lwd_70
    s_sleep 2
    s_branch L_lw_69
L_lwd_70:
    s_cmp_lt_u32 s44, s52
    s_cbranch_scc1 L_has_down
    v_mov_b32 v8, 0
    v_mov_b32 v9, 0
    v_mov_b32 v10, 0
    v_mov_b32 v11, 0
    s_mov_b64 exec, 0xf
    buffer_store_dwordx4 v[8:11], v6, s[12:15], s65 offen sc1
    s_mov_b64 exec, -1
L_has_down:
    s_mov_b32 s54, 0
L_lw_71:
    ds_read_b32 v8, v5 offset:4
    s_add_u32 s54, s54, 1
    s_waitcnt lgkmcnt(0)
    v_readfirstlane_b32 s53, v8
    s_cmp_gt_u32 s54, 1048576
    s_cbranch_scc1 L_lwd_72
    s_cmp_ge_u32 s53, 1
    s_cbranch_scc1 L_lwd_72
    s_branch L_lw_71
L_lwd_72:
    s_mov_b32 s54, 0
L_poll_73:
    buffer_load_dwordx4 v[24:27], v113, s[12:15], s61 offen offset:0 sc1
    buffer_load_dwordx4 v[28:31], v113, s[12:15], s61 offen offset:64 sc1
    buffer_load_dwordx4 v[32:35], v113, s[12:15], s61 offen offset:128 sc1
    buffer_load_dwordx4 v[36:39], v113, s[12:15], s61 offen offset:192 sc1
    s_waitcnt vmcnt(0)
    v_mfma_f32_16x16x32_bf16 v[8:11], v[24:27], v[64:67], 0
    v_mfma_f32_16x16x32_bf16 v[8:11], v[28:31], v[68:71], v[8:11]
    v_mfma_f32_16x16x32_bf16 v[8:11], v[32:35], v[72:75], v[8:11]
    v_mfma_f32_16x16x32_bf16 v[8:11], v[36:39], v[76:79], v[8:11]
    v_pk_max_u16 v16, v24, v25
    v_pk_max_u16 v16, v16, v26
    v_pk_max_u16 v16, v16, v27
    v_pk_max_u16 v16, v16, v28
    v_pk_max_u16 v16, v16, v29
    v_pk_max_u16 v16, v16, v30
    v_pk_max_u16 v16, v16, v31
    v_pk_max_u16 v16, v16, v32
    v_pk_max_u16 v16, v16, v33
    v_pk_max_u16 v16, v16, v34
    v_pk_max_u16 v16, v16, v35
    v_pk_max_u16 v16, v16, v36
    v_pk_max_u16 v16, v16, v37
    v_pk_max_u16 v16, v16, v38
    v_pk_max_u16 v16, v16, v39
    v_lshrrev_b32 v17, 16, v16
    v_max_u16 v16, v16, v17
    v_cmp_eq_u16 vcc, -1, v16
    s_add_u32 s54, s54, 1
    s_cmp_gt_u32 s54, 262144
    s_cbranch_scc1 L_pd_74
    s_cbranch_vccnz L_poll_73
L_pd_74:
    v_mov_b32_dpp v9, v8 row_ror:12 row_mask:0xf bank_mask:0xf
    v_mov_b32_dpp v10, v8 row_ror:8 row_mask:0xf bank_mask:0xf
    v_mov_b32_dpp v11, v8 row_ror:4 row_mask:0xf bank_mask:0xf
    s_mov_b64 exec, 0xffffffff
    buffer_store_dwordx4 v[8:11], v115, s[12:15], s64 offen sc1
    s_mov_b64 exec, -1
    v_mov_b32 v13, 1
    s_mov_b64 exec, 1
    ds_add_u32 v5, v13 offset:44
    s_mov_b64 exec, -1
    s_mov_b32 s54, 0
L_lw_75:
    ds_read_b32 v8, v5 offset:48
    s_add_u32 s54, s54, 1
    s_waitcnt lgkmcnt(0)
    v_readfirstlane_b32 s53, v8
    s_cmp_gt_u32 s54, 1048576
    s_cbranch_scc1 L_lwd_76
    s_cmp_ge_u32 s53, 8
    s_cbranch_scc1 L_lwd_76
    s_branch L_lw_75
L_lwd_76:
    v_add_u32 v59, 79872, v58
    ds_read_b64_tr_b16 v[80:81], v59 offset:0
    ds_read_b64_tr_b16 v[82:83], v59 offset:512
    ds_read_b64_tr_b16 v[84:85], v59 offset:4096
    ds_read_b64_tr_b16 v[86:87], v59 offset:4608
    ds_read_b64_tr_b16 v[88:89], v59 offset:8192
    ds_read_b64_tr_b16 v[90:91], v59 offset:8704
    ds_read_b64_tr_b16 v[92:93], v59 offset:12288
    ds_read_b64_tr_b16 v[94:95], v59 offset:12800
    v_add_u32 v59, 22528, v58
    ds_read_b64_tr_b16 v[96:97], v59 offset:0
    ds_read_b64_tr_b16 v[98:99], v59 offset:512
    ds_read_b64_tr_b16 v[100:101], v59 offset:4096
    ds_read_b64_tr_b16 v[102:103], v59 offset:4608
    s_mov_b32 s54, 0
L_lw_77:
    ds_read_b32 v8, v5 offset:4
    s_add_u32 s54, s54, 1
    s_waitcnt lgkmcnt(0)
    v_readfirstlane_b32 s53, v8
    s_cmp_gt_u32 s54, 1048576
    s_cbranch_scc1 L_lwd_78
    s_cmp_ge_u32 s53, 2
    s_cbranch_scc1 L_lwd_78
    s_branch L_lw_77
L_lwd_78:
    s_and_b32 s59, s45, 3
    s_cmp_ge_u32 s59, s52
    s_cbranch_scc1 L_gu
    s_mov_b32 s54, 0
L_poll_79:
    buffer_load_dwordx4 v[8:11], v6, s[12:15], s61 offen offset:1024 sc1
    buffer_load_dword v12, v114, s[12:15], s61 offen offset:1024 sc1
    s_waitcnt vmcnt(0)
    v_pk_max_u16 v16, v8, v9
    v_pk_max_u16 v17, v10, v11
    v_pk_max_u16 v16, v16, v12
    v_pk_max_u16 v16, v16, v17
    v_lshrrev_b32 v17, 16, v16
    v_max_u16 v16, v16, v17
    v_cmp_eq_u16 vcc, -1, v16
    s_add_u32 s54, s54, 1
    s_cmp_gt_u32 s54, 262144
    s_cbranch_scc1 L_pd_80
    s_cbranch_vccnz L_poll_79
L_pd_80:
    v_lshlrev_b32 v24, 16, v8
    v_and_b32 v25, 0xffff0000, v8
    v_lshlrev_b32 v26, 16, v9
    v_and_b32 v27, 0xffff0000, v9
    v_lshlrev_b32 v28, 16, v10
    v_and_b32 v29, 0xffff0000, v10
    v_lshlrev_b32 v30, 16, v11
    v_and_b32 v31, 0xffff0000, v11
    v_readfirstlane_b32 s55, v24
    s_nop 1
    v_sub_f32 v32, 0, s55
    v_sub_f32 v33, 0, s55
    v_pk_add_f32 v[24:25], v[24:25], v[32:33]
    v_pk_add_f32 v[26:27], v[26:27], v[32:33]
    v_pk_add_f32 v[28:29], v[28:29], v[32:33]
    v_pk_add_f32 v[30:31], v[30:31], v[32:33]
    v_pk_mul_f32 v[34:35], v[24:25], v[24:25]
    v_pk_add_f32 v[32:33], v[24:25], v[26:27]
    v_pk_fma_f32 v[34:35], v[26:27], v[26:27], v[34:35]
    v_pk_fma_f32 v[34:35], v[28:29], v[28:29], v[34:35]
    v_pk_add_f32 v[32:33], v[32:33], v[28:29]
    v_pk_fma_f32 v[34:35], v[30:31], v[30:31], v[34:35]
    v_pk_add_f32 v[32:33], v[32:33], v[30:31]
    v_add_f32 v35, v34, v35
    v_add_f32 v34, v32, v33
    s_nop 1
    v_permlane32_swap_b32 v34, v35
    v_add_f32 v34, v34, v35
    v_mov_b32 v35, v34
    s_nop 1
    v_permlane16_swap_b32 v34, v35
    v_add_f32 v34, v34, v35
    s_nop 1
    v_add_f32_dpp v34, v34, v34 row_ror:8 row_mask:0xf bank_mask:0xf
    s_nop 1
    v_add_f32_dpp v34, v34, v34 row_ror:4 row_mask:0xf bank_mask:0xf
    s_nop 1
    v_add_f32_dpp v34, v34, v34 row_ror:2 row_mask:0xf bank_mask:0xf
    s_nop 1
    v_add_f32_dpp v34, v34, v34 row_ror:1 row_mask:0xf bank_mask:0xf
    v_mul_f32 v34, 0x3b000000, v34
    s_nop 0
    v_readlane_b32 s56, v34, 0
    v_readlane_b32 s57, v34, 32
    s_nop 0
    v_mov_b32 v35, s56
    v_fma_f32 v34, -v35, v35, s57
    v_add_f32 v35, s55, v35
    v_cvt_pk_bf16_f32 v32, v34, v35
    v_lshlrev_b32 v34, 16, v32
    v_and_b32 v32, 0xffff0000, v32
    v_max_f32 v34, 0, v34
    v_add_f32 v34, 0x3727c5ac, v34
    v_cvt_pk_bf16_f32 v34, v34, v34
    v_and_b32 v34, 0xffff0000, v34
    v_sqrt_f32 v34, v34
    s_nop 0
    v_cvt_pk_bf16_f32 v34, v34, v34
    v_and_b32 v34, 0xffff0000, v34
    v_rcp_f32 v33, v34
    s_nop 0
    v_lshlrev_b32 v20, 16, v12
    v_and_b32 v21, 0xffff0000, v12
    v_sub_f32 v20, v20, v32
    v_sub_f32 v21, v21, v32
    v_cvt_pk_bf16_f32 v22, v20, v21
    v_lshlrev_b32 v20, 16, v22
    v_and_b32 v21, 0xffff0000, v22
    v_mul_f32 v20, v33, v20
    v_mul_f32 v21, v33, v21
    v_cvt_pk_bf16_f32 v22, v20, v21
    v_lshlrev_b32 v20, 16, v22
    v_and_b32 v21, 0xffff0000, v22
    v_mul_f32 v20, v110, v20
    v_mul_f32 v21, v111, v21
    v_cvt_pk_bf16_f32 v22, v20, v21
    v_lshlrev_b32 v20, 16, v22
    v_and_b32 v21, 0xffff0000, v22
    v_add_f32 v20, v108, v20
    v_add_f32 v21, v109, v21
    v_cvt_pk_bf16_f32 v22, v20, v21
    ds_write_b32 v116, v22
    ds_read_b128 v[24:27], v117 offset:0
    ds_read_b128 v[28:31], v117 offset:64
    ds_read_b128 v[32:35], v117 offset:128
    ds_read_b128 v[36:39], v117 offset:192
    s_waitcnt lgkmcnt(0)
    v_mfma_f32_16x16x32_bf16 v[8:11], v[80:83], v[24:27], 0
    v_mfma_f32_16x16x32_bf16 v[8:11], v[84:87], v[28:31], v[8:11]
    v_mfma_f32_16x16x32_bf16 v[8:11], v[88:91], v[32:35], v[8:11]
    v_mfma_f32_16x16x32_bf16 v[8:11], v[92:95], v[36:39], v[8:11]
    s_mov_b64 exec, s[68:69]
    s_nop 5
    s_cmp_eq_u32 s6, 1
    s_cbranch_scc0 L_slow_81
    buffer_store_dwordx4 v[8:11], v112, s[12:15], s47 offen
L_back_82:
    s_mov_b64 exec, -1
L_gu:
    s_cmp_ge_u32 s44, s52
    s_cbranch_scc1 L_hend
    s_mov_b32 s54, 0
L_poll_83:
    buffer_load_dword v8, v114, s[12:15], s62 offen offset:0 sc1
    buffer_load_dword v12, v114, s[12:15], s62 offen offset:1024 sc1
    buffer_load_dword v9, v114, s[12:15], s62 offen offset:2048 sc1
    buffer_load_dword v13, v114, s[12:15], s62 offen offset:3072 sc1
    buffer_load_dword v10, v114, s[12:15], s63 offen offset:0 sc1
    buffer_load_dword v14, v114, s[12:15], s63 offen offset:1024 sc1
    buffer_load_dword v11, v114, s[12:15], s63 offen offset:2048 sc1
    buffer_load_dword v15, v114, s[12:15], s63 offen offset:3072 sc1
    s_waitcnt vmcnt(0)
    v_max3_u32 v16, v8, v9, v10
    v_max3_u32 v16, v16, v11, v12
    v_max3_u32 v16, v16, v13, v14
    v_max_u32 v16, v16, v15
    v_cmp_eq_u32 vcc, -1, v16
    v_add_f32 v8, v8, v9
    v_add_f32 v12, v12, v13
    v_add_f32 v8, v8, v10
    v_add_f32 v12, v12, v14
    v_add_f32 v8, v8, v11
    v_add_f32 v12, v12, v15
    s_add_u32 s54, s54, 1
    s_cmp_gt_u32 s54, 262144
    s_cbranch_scc1 L_pd_84
    s_cbranch_vccnz L_poll_83
L_pd_84:
    v_cvt_pk_bf16_f32 v12, v8, v12
    v_lshlrev_b32 v8, 16, v12
    v_and_b32 v12, 0xffff0000, v12
    v_mul_f32 v9, v8, v8
    v_mul_f32 v9, 0x3d372713, v9
    v_fma_f32 v9, v9, v8, v8
    v_mul_f32 v9, 0xc0135761, v9
    v_exp_f32 v9, v9
    s_nop 0
    v_add_f32 v9, 1.0, v9
    v_rcp_f32 v9, v9
    s_nop 0
    v_mul_f32 v8, v8, v9
    v_cvt_pk_bf16_f32 v8, v8, v8
    v_and_b32 v8, 0xffff0000, v8
    v_mul_f32 v8, v8, v12
    v_cvt_pk_bf16_f32 v8, v8, v8
    ds_write_b16 v119, v8
    ds_read_b128 v[24:27], v117 offset:0
    ds_read_b128 v[28:31], v117 offset:64
    s_waitcnt lgkmcnt(0)
    v_mfma_f32_16x16x32_bf16 v[8:11], v[24:27], v[96:99], 0
    v_mfma_f32_16x16x32_bf16 v[8:11], v[28:31], v[100:103], v[8:11]
    s_nop 7
    v_mov_b32_dpp v9, v8 row_ror:12 row_mask:0xf bank_mask:0xf
    v_mov_b32_dpp v10, v8 row_ror:8 row_mask:0xf bank_mask:0xf
    v_mov_b32_dpp v11, v8 row_ror:4 row_mask:0xf bank_mask:0xf
    s_mov_b64 exec, s[26:27]
    buffer_store_dwordx4 v[8:11], v118, s[12:15], s65 offen sc1
    s_mov_b64 exec, -1
L_hend:
    v_mov_b32 v13, 1
    s_mov_b64 exec, 1
    ds_add_u32 v5, v13 offset:44
    s_mov_b64 exec, -1
L_exit:
    s_endpgm
L_probe:
    s_add_u32 s62, s42, 786432
    s_addc_u32 s63, s43, 0
    s_mov_b32 s64, -1
    s_mov_b32 s65, -1
    s_memtime s[66:67]
    s_waitcnt lgkmcnt(0)
    s_load_dword s61, s[62:63], 0x0
    s_waitcnt lgkmcnt(0)
    s_memtime s[68:69]
    s_waitcnt lgkmcnt(0)
    s_sub_u32 s66, s68, s66
    s_min_u32 s64, s64, s66
    s_memtime s[66:67]
    s_waitcnt lgkmcnt(0)
    s_load_dword s61, s[62:63], 0x2000
    s_waitcnt lgkmcnt(0)
    s_memtime s[68:69]
    s_waitcnt lgkmcnt(0)
    s_sub_u32 s66, s68, s66
    s_min_u32 s65, s65, s66
    s_memtime s[66:67]
    s_waitcnt lgkmcnt(0)
    s_load_dword s61, s[62:63], 0x4100
    s_waitcnt lgkmcnt(0)
    s_memtime s[68:69]
    s_waitcnt lgkmcnt(0)
    s_sub_u32 s66, s68, s66
    s_min_u32 s64, s64, s66
    s_memtime s[66:67]
    s_waitcnt lgkmcnt(0)
    s_load_dword s61, s[62:63], 0x6100
    s_waitcnt lgkmcnt(0)
    s_memtime s[68:69]
    s_waitcnt lgkmcnt(0)
    s_sub_u32 s66, s68, s66
    s_min_u32 s65, s65, s66
    s_memtime s[66:67]
    s_waitcnt lgkmcnt(0)
    s_load_dword s61, s[62:63], 0x8200
    s_waitcnt lgkmcnt(0)
    s_memtime s[68:69]
    s_waitcnt lgkmcnt(0)
    s_sub_u32 s66, s68, s66
    s_min_u32 s64, s64, s66
    s_memtime s[66:67]
    s_waitcnt lgkmcnt(0)
    s_load_dword s61, s[62:63], 0xa200
    s_waitcnt lgkmcnt(0)
    s_memtime s[68:69]
    s_waitcnt lgkmcnt(0)
    s_sub_u32 s66, s68, s66
    s_min_u32 s65, s65, s66
    s_memtime s[66:67]
    s_waitcnt lgkmcnt(0)
    s_load_dword s61, s[62:63], 0xc300
    s_waitcnt lgkmcnt(0)
    s_memtime s[68:69]
    s_waitcnt lgkmcnt(0)
    s_sub_u32 s66, s68, s66
    s_min_u32 s64, s64, s66
    s_memtime s[66:67]
    s_waitcnt lgkmcnt(0)
    s_load_dword s61, s[62:63], 0xe300
    s_waitcnt lgkmcnt(0)
    s_memtime s[68:69]
    s_waitcnt lgkmcnt(0)
    s_sub_u32 s66, s68, s66
    s_min_u32 s65, s65, s66
    s_cmp_lt_u32 s65, s64
    s_cselect_b32 s64, 2, 1
    v_mov_b32 v7, s64
    ds_write_b32 v5, v7 offset:224
    s_branch L_vmain
L_v0b:
    s_waitcnt vmcnt(0) lgkmcnt(0)
    s_mul_i32 s7, s7, 0x9e3779b1
    s_add_u32 s7, s7, 0x7f4a7c15
    v_mov_b32 v13, 16
    s_mov_b64 exec, 1
    ds_add_u32 v5, v13 offset:12
    s_mov_b64 exec, -1
    v_mov_b32 v12, s66
    v_mov_b32 v13, s7
    s_lshl_b32 s59, s4, 8
    s_add_u32 s59, s59, 4096
    s_lshl_b32 s61, s5, 3
    s_add_u32 s67, s61, s59
    s_add_u32 s68, s67, 4096
    s_mov_b64 exec, 1
    buffer_store_dwordx2 v[12:13], v5, s[12:15], s67 offen
    buffer_store_dwordx2 v[12:13], v5, s[12:15], s68 offen sc1
    s_mov_b64 exec, 0xffff
    s_mov_b32 s54, 0
L_pb_27:
    s_sleep 2
    buffer_load_dwordx4 v[8:11], v6, s[12:15], s59 offen sc1
    s_add_u32 s54, s54, 1
    s_waitcnt vmcnt(0)
    v_xor_b32 v9, s7, v9
    v_xor_b32 v11, s7, v11
    v_or_b32 v16, v9, v11
    v_cmp_ne_u32 vcc, 0, v16
    s_cmp_gt_u32 s54, 256
    s_cbranch_scc1 L_v0_far
    s_cbranch_vccnz L_pb_27
L_pbd_28:
L_v0_census:
    v_mov_b32_dpp v16, v8 row_ror:1 row_mask:0xf bank_mask:0xf
    v_xor_b32 v18, v8, v10
    v_xor_b32 v16, v16, v8
    v_or_b32 v16, v16, v18
    v_cmp_ne_u32 vcc, 0, v16
    s_nop 3
    s_cbranch_vccz L_mode_done
    s_mov_b64 exec, -1
    s_mov_b32 s6, 2
    v_mov_b32 v8, -1
    v_mov_b32 v9, -1
    v_mov_b32 v10, -1
    v_mov_b32 v11, -1
    s_mul_i32 s61, s4, 90112
    s_add_u32 s61, s61, 2097152
    s_lshl_b32 s62, s5, 11
    s_add_u32 s62, s62, s61
    s_add_u32 s62, s62, 24576
    s_mul_i32 s63, s5, 768
    s_add_u32 s63, s63, s61
    buffer_store_dwordx4 v[8:11], v6, s[12:15], s62 offen sc1
    buffer_store_dwordx4 v[8:11], v6, s[12:15], s62 offen offset:1024 sc1
    s_mov_b32 s64, -1
    s_mov_b32 s65, 0xffff
    s_mov_b64 exec, s[64:65]
    buffer_store_dwordx4 v[8:11], v6, s[12:15], s63 offen sc1
    s_mov_b64 exec, -1
    s_waitcnt vmcnt(0)
    s_add_u32 s68, s67, 8192
    s_mov_b64 exec, 1
    buffer_store_dwordx2 v[12:13], v5, s[12:15], s68 offen sc1
    s_lshl_b32 s59, s4, 8
    s_add_u32 s59, s59, 12288
    s_mov_b64 exec, 0xffff
    s_mov_b32 s54, 0
L_pb_29:
    s_sleep 2
    buffer_load_dwordx4 v[8:11], v6, s[12:15], s59 offen sc1
    s_add_u32 s54, s54, 1
    s_waitcnt vmcnt(0)
    v_xor_b32 v9, s7, v9
    v_xor_b32 v11, s7, v11
    v_or_b32 v16, v9, v11
    v_cmp_ne_u32 vcc, 0, v16
    s_cmp_gt_u32 s54, 262144
    s_cbranch_scc1 L_pbd_30
    s_cbranch_vccnz L_pb_29
L_pbd_30:
    s_branch L_mode_done
L_v0_far:
    s_add_u32 s59, s59, 4096
    s_mov_b64 exec, 0xffff
    s_mov_b32 s54, 0
L_pb_31:
    s_sleep 2
    buffer_load_dwordx4 v[8:11], v6, s[12:15], s59 offen sc1
    s_add_u32 s54, s54, 1
    s_waitcnt vmcnt(0)
    v_xor_b32 v9, s7, v9
    v_xor_b32 v11, s7, v11
    v_or_b32 v16, v9, v11
    v_cmp_ne_u32 vcc, 0, v16
    s_cmp_gt_u32 s54, 262144
    s_cbranch_scc1 L_pbd_32
    s_cbranch_vccnz L_pb_31
L_pbd_32:
    s_branch L_v0_census
L_mode_done:
    s_mov_b64 exec, -1
    v_mov_b32 v12, s6
    ds_write_b32 v5, v12 offset:8
    s_cmp_lg_u32 s5, 0
    s_cbranch_scc1 L_v0_nogb
    s_mov_b32 s53, 1
    s_cmp_lg_u32 s2, 0
    s_cbranch_scc1 L_v0_phi
    s_mov_b32 s54, 0
L_lw_33:
    ds_read_b32 v12, v5 offset:224
    s_add_u32 s54, s54, 1
    s_waitcnt lgkmcnt(0)
    v_readfirstlane_b32 s53, v12
    s_cmp_gt_u32 s54, 1048576
    s_cbranch_scc1 L_lwd_34
    s_cmp_lg_u32 s53, 0
    s_cbranch_scc1 L_lwd_34
    s_sleep 2
    s_branch L_lw_33
L_lwd_34:
L_v0_phi:
    s_sub_u32 s53, s53, 1
    s_and_b32 s53, s53, 1
    v_mov_b32 v12, s53
    v_mov_b32 v13, s7
    s_lshl_b32 s59, s4, 3
    s_mov_b64 exec, 1
    buffer_store_dwordx2 v[12:13], v5, s[12:15], s59 offen offset:2048 sc1
    s_mov_b64 exec, -1
L_v0_nogb:
L_vmain:
    v_mov_b32 v8, 0
    v_mov_b32 v9, 0
    v_mov_b32 v10, 0
    v_mov_b32 v11, 0
    v_mov_b32 v12, 0
    v_mov_b32 v13, 0
    v_mov_b32 v14, 0
    v_mov_b32 v15, 0
    v_mov_b32 v16, 0
    v_mov_b32 v17, 0
    v_mov_b32 v18, 0
    v_mov_b32 v19, 0
    v_mov_b32 v20, 0
    v_mov_b32 v21, 0
    v_mov_b32 v22, 0
    v_mov_b32 v23, 0
    v_mov_b32 v24, 0
    v_mov_b32 v25, 0
    v_mov_b32 v26, 0
    v_mov_b32 v27, 0
    v_mov_b32 v7, 0xffff
    v_mov_b32 v36, 0xffff0000
    s_mov_b32 s62, 0x11111111
    s_mov_b32 s63, 0x11111111
    s_mov_b32 s64, 0x22222222
    s_mov_b32 s65, 0x22222222
    s_mov_b32 s66, 0x44444444
    s_mov_b32 s67, 0x44444444
    s_mov_b32 s68, 0x88888888
    s_mov_b32 s69, 0x88888888
    v_cndmask_b32 v26, v26, v7, s[62:63]
    v_cndmask_b32 v26, v26, v36, s[64:65]
    v_cndmask_b32 v27, v27, v7, s[66:67]
    v_cndmask_b32 v27, v27, v36, s[68:69]
    v_lshl_add_u32 v37, v2, 2, v3
    v_mul_u32_u24 v37, 144, v37
    s_mul_i32 s59, s60, 2304
    v_add_u32 v37, s59, v37
    v_lshrrev_b32 v28, 3, v0
    v_and_b32 v29, 7, v0
    v_lshlrev_b32 v29, 4, v29
    v_lshl_add_u32 v30, v28, 10, v29
    s_mov_b32 s48, s24
    s_mov_b32 s49, s25
    s_mov_b32 s50, 0x400000
    s_mov_b32 s51, 0x20000
    s_waitcnt vmcnt(0)
    s_lshl_b32 s59, s60, 2
    v_mov_b32 v38, s59
    s_mov_b32 s54, 0
L_lw_35:
    ds_read_b32 v7, v38 offset:16
    s_add_u32 s54, s54, 1
    s_waitcnt lgkmcnt(0)
    v_readfirstlane_b32 s53, v7
    s_cmp_gt_u32 s54, 1048576
    s_cbranch_scc1 L_lwd_36
    s_cmp_ge_u32 s53, 1
    s_cbranch_scc1 L_lwd_36
    s_sleep 2
    s_branch L_lw_35
L_lwd_36:
    s_lshl_b32 s59, s4, 19
    s_lshl_b32 s61, s44, 17
    s_add_u32 s59, s59, s61
    s_lshl_b32 s61, s60, 15
    s_add_u32 s59, s59, s61
    s_lshl_b32 s61, s45, 7
    s_add_u32 s59, s59, s61
    s_lshl_b32 s62, s60, 12
    s_add_u32 s62, s62, 63488
    s_mov_b32 m0, s62
    s_nop 0
    buffer_load_dwordx4 v30, s[48:51], s59 offen nt lds
    s_add_u32 s59, s59, 8192
    s_add_u32 s62, s62, 1024
    s_mov_b32 m0, s62
    s_nop 0
    buffer_load_dwordx4 v30, s[48:51], s59 offen nt lds
    s_add_u32 s59, s59, 8192
    s_add_u32 s62, s62, 1024
    s_mov_b32 m0, s62
    s_nop 0
    buffer_load_dwordx4 v30, s[48:51], s59 offen nt lds
    s_add_u32 s59, s59, 8192
    s_add_u32 s62, s62, 1024
    s_mov_b32 m0, s62
    s_nop 0
    buffer_load_dwordx4 v30, s[48:51], s59 offen nt lds
    s_add_u32 s59, s59, 8192
    s_add_u32 s62, s62, 1024
    s_waitcnt vmcnt(4)
    buffer_load_dwordx4 v[40:43], v6, s[8:11], s58 offen nt
    s_add_u32 s58, s58, 4096
    s_waitcnt vmcnt(4)
    buffer_load_dwordx4 v[44:47], v6, s[8:11], s58 offen nt
    s_add_u32 s58, s58, 4096
    s_waitcnt vmcnt(4)
    buffer_load_dwordx4 v[48:51], v6, s[8:11], s58 offen nt
    s_add_u32 s58, s58, 4096
    s_waitcnt vmcnt(4)
    buffer_load_dwordx4 v[52:55], v6, s[8:11], s58 offen nt
    s_add_u32 s58, s58, 4096
    s_waitcnt vmcnt(4)
    buffer_load_dwordx4 v[56:59], v6, s[8:11], s58 offen nt
    s_add_u32 s58, s58, 4096
    s_waitcnt vmcnt(4)
    v_mov_b32 v7, 1
    s_mov_b64 exec, 1
    ds_add_u32 v5, v7 offset:48
    s_mov_b64 exec, -1
    buffer_load_dwordx4 v[60:63], v6, s[8:11], s58 offen nt
    s_add_u32 s58, s58, 4096
    s_waitcnt vmcnt(4)
    buffer_load_dwordx4 v[64:67], v6, s[8:11], s58 offen nt
    s_add_u32 s58, s58, 4096
    s_waitcnt vmcnt(4)
    buffer_load_dwordx4 v[68:71], v6, s[8:11], s58 offen nt
    s_add_u32 s58, s58, 4096
    s_waitcnt vmcnt(4)
    buffer_load_dwordx4 v[72:75], v6, s[8:11], s58 offen nt
    s_add_u32 s58, s58, 4096
    s_waitcnt vmcnt(4)
    buffer_load_dwordx4 v[76:79], v6, s[8:11], s58 offen nt
    s_add_u32 s58, s58, 4096
    s_waitcnt vmcnt(4)
    buffer_load_dwordx4 v[80:83], v6, s[8:11], s58 offen nt
    s_add_u32 s58, s58, 4096
    s_waitcnt vmcnt(4)
    buffer_load_dwordx4 v[84:87], v6, s[8:11], s58 offen nt
    s_add_u32 s58, s58, 4096
    ds_read_b32 v39, v38 offset:16
    s_waitcnt vmcnt(4)
    s_waitcnt lgkmcnt(0)
    v_readfirstlane_b32 s53, v39
    s_cmp_ge_u32 s53, 2
    s_cbranch_scc1 L_vp_12
    buffer_load_dwordx4 v[88:91], v6, s[8:11], s58 offen nt
    s_add_u32 s58, s58, 4096
    s_waitcnt vmcnt(4)
    buffer_load_dwordx4 v[92:95], v6, s[8:11], s58 offen nt
    s_add_u32 s58, s58, 4096
    s_waitcnt vmcnt(4)
    buffer_load_dwordx4 v[96:99], v6, s[8:11], s58 offen nt
    s_add_u32 s58, s58, 4096
    s_waitcnt vmcnt(4)
    buffer_load_dwordx4 v[100:103], v6, s[8:11], s58 offen nt
    s_add_u32 s58, s58, 4096
    ds_read_b32 v39, v38 offset:16
    s_waitcnt vmcnt(4)
    s_waitcnt lgkmcnt(0)
    v_readfirstlane_b32 s53, v39
    s_cmp_ge_u32 s53, 2
    s_cbranch_scc1 L_vp_16
    buffer_load_dwordx4 v[104:107], v6, s[8:11], s58 offen nt
    s_add_u32 s58, s58, 4096
    s_waitcnt vmcnt(4)
    buffer_load_dwordx4 v[108:111], v6, s[8:11], s58 offen nt
    s_add_u32 s58, s58, 4096
    s_waitcnt vmcnt(4)
    buffer_load_dwordx4 v[112:115], v6, s[8:11], s58 offen nt
    s_add_u32 s58, s58, 4096
    s_waitcnt vmcnt(4)
    buffer_load_dwordx4 v[116:119], v6, s[8:11], s58 offen nt
    s_add_u32 s58, s58, 4096
    ds_read_b32 v39, v38 offset:16
    s_waitcnt vmcnt(4)
    s_waitcnt lgkmcnt(0)
    v_readfirstlane_b32 s53, v39
    s_cmp_ge_u32 s53, 2
    s_cbranch_scc1 L_vp_20
    buffer_load_dwordx4 v[120:123], v6, s[8:11], s58 offen nt
    s_add_u32 s58, s58, 4096
    s_waitcnt vmcnt(4)
    buffer_load_dwordx4 v[124:127], v6, s[8:11], s58 offen nt
    s_add_u32 s58, s58, 4096
    s_waitcnt vmcnt(4)
    buffer_load_dwordx4 v[128:131], v6, s[8:11], s58 offen nt
    s_add_u32 s58, s58, 4096
    s_waitcnt vmcnt(4)
    buffer_load_dwordx4 v[132:135], v6, s[8:11], s58 offen nt
    s_add_u32 s58, s58, 4096
    ds_read_b32 v39, v38 offset:16
    s_waitcnt vmcnt(4)
    s_waitcnt lgkmcnt(0)
    v_readfirstlane_b32 s53, v39
    s_cmp_ge_u32 s53, 2
    s_cbranch_scc1 L_vp_24
    buffer_load_dwordx4 v[136:139], v6, s[8:11], s58 offen nt
    s_add_u32 s58, s58, 4096
    s_waitcnt vmcnt(4)
    buffer_load_dwordx4 v[140:143], v6, s[8:11], s58 offen nt
    s_add_u32 s58, s58, 4096
    s_waitcnt vmcnt(4)
    buffer_load_dwordx4 v[144:147], v6, s[8:11], s58 offen nt
    s_add_u32 s58, s58, 4096
    s_waitcnt vmcnt(4)
    buffer_load_dwordx4 v[148:151], v6, s[8:11], s58 offen nt
    s_add_u32 s58, s58, 4096
    ds_read_b32 v39, v38 offset:16
    s_waitcnt vmcnt(4)
    s_waitcnt lgkmcnt(0)
    v_readfirstlane_b32 s53, v39
    s_cmp_ge_u32 s53, 2
    s_cbranch_scc1 L_vp_28
    buffer_load_dwordx4 v[152:155], v6, s[8:11], s58 offen nt
    s_add_u32 s58, s58, 4096
    s_waitcnt vmcnt(4)
    buffer_load_dwordx4 v[156:159], v6, s[8:11], s58 offen nt
    s_add_u32 s58, s58, 4096
    s_waitcnt vmcnt(4)
    buffer_load_dwordx4 v[160:163], v6, s[8:11], s58 offen nt
    s_add_u32 s58, s58, 4096
    s_waitcnt vmcnt(4)
    buffer_load_dwordx4 v[164:167], v6, s[8:11], s58 offen nt
    s_add_u32 s58, s58, 4096
    v_mov_b32 v7, 1
    s_mov_b64 exec, 1
    ds_add_u32 v5, v7 offset:12
    s_mov_b64 exec, -1
    s_mov_b32 s54, 0
L_lw_37:
    ds_read_b32 v7, v38 offset:16
    s_add_u32 s54, s54, 1
    s_waitcnt lgkmcnt(0)
    v_readfirstlane_b32 s53, v7
    s_cmp_gt_u32 s54, 1048576
    s_cbranch_scc1 L_lwd_38
    s_cmp_ge_u32 s53, 2
    s_cbranch_scc1 L_lwd_38
    s_sleep 1
    s_branch L_lw_37
L_lwd_38:
    ds_read_b32 v39, v5 offset:0
    ds_read_b128 v[28:31], v37 offset:2560
    ds_read_b128 v[32:35], v37 offset:2576
    s_waitcnt lgkmcnt(0)
    v_readfirstlane_b32 s6, v39
    v_and_b32 v10, v28, v26
    v_and_b32 v11, v28, v27
    v_and_b32 v14, v29, v26
    v_and_b32 v15, v29, v27
    s_waitcnt vmcnt(31)
    v_mfma_f32_16x16x32_bf16 v[18:21], v[10:13], v[40:43], v[18:21]
    v_mfma_f32_16x16x32_bf16 v[22:25], v[8:11], v[40:43], v[22:25]
    v_and_b32 v10, v30, v26
    v_and_b32 v11, v30, v27
    s_waitcnt vmcnt(30)
    v_mfma_f32_16x16x32_bf16 v[18:21], v[14:17], v[44:47], v[18:21]
    v_mfma_f32_16x16x32_bf16 v[22:25], v[12:15], v[44:47], v[22:25]
    v_and_b32 v14, v31, v26
    v_and_b32 v15, v31, v27
    s_waitcnt vmcnt(29)
    v_mfma_f32_16x16x32_bf16 v[18:21], v[10:13], v[48:51], v[18:21]
    v_mfma_f32_16x16x32_bf16 v[22:25], v[8:11], v[48:51], v[22:25]
    v_and_b32 v10, v32, v26
    v_and_b32 v11, v32, v27
    s_waitcnt vmcnt(28)
    v_mfma_f32_16x16x32_bf16 v[18:21], v[14:17], v[52:55], v[18:21]
    v_mfma_f32_16x16x32_bf16 v[22:25], v[12:15], v[52:55], v[22:25]
    v_and_b32 v14, v33, v26
    v_and_b32 v15, v33, v27
    s_waitcnt vmcnt(27)
    v_mfma_f32_16x16x32_bf16 v[18:21], v[10:13], v[56:59], v[18:21]
    v_mfma_f32_16x16x32_bf16 v[22:25], v[8:11], v[56:59], v[22:25]
    v_and_b32 v10, v34, v26
    v_and_b32 v11, v34, v27
    s_waitcnt vmcnt(26)
    v_mfma_f32_16x16x32_bf16 v[18:21], v[14:17], v[60:63], v[18:21]
    v_mfma_f32_16x16x32_bf16 v[22:25], v[12:15], v[60:63], v[22:25]
    v_and_b32 v14, v35, v26
    v_and_b32 v15, v35, v27
    s_waitcnt vmcnt(25)
    v_mfma_f32_16x16x32_bf16 v[18:21], v[10:13], v[64:67], v[18:21]
    v_mfma_f32_16x16x32_bf16 v[22:25], v[8:11], v[64:67], v[22:25]
    ds_read_b128 v[40:43], v37 offset:2592
    ds_read_b128 v[44:47], v37 offset:2608
    ds_read_b128 v[48:51], v37 offset:2624
    ds_read_b128 v[52:55], v37 offset:2640
    ds_read_b128 v[56:59], v37 offset:2656
    ds_read_b128 v[60:63], v37 offset:2672
    s_waitcnt lgkmcnt(0)
    v_and_b32 v10, v40, v26
    v_and_b32 v11, v40, v27
    s_waitcnt vmcnt(24)
    v_mfma_f32_16x16x32_bf16 v[18:21], v[14:17], v[68:71], v[18:21]
    v_mfma_f32_16x16x32_bf16 v[22:25], v[12:15], v[68:71], v[22:25]
    v_and_b32 v14, v41, v26
    v_and_b32 v15, v41, v27
    s_waitcnt vmcnt(23)
    v_mfma_f32_16x16x32_bf16 v[18:21], v[10:13], v[72:75], v[18:21]
    v_mfma_f32_16x16x32_bf16 v[22:25], v[8:11], v[72:75], v[22:25]
    v_and_b32 v10, v42, v26
    v_and_b32 v11, v42, v27
    s_waitcnt vmcnt(22)
    v_mfma_f32_16x16x32_bf16 v[18:21], v[14:17], v[76:79], v[18:21]
    v_mfma_f32_16x16x32_bf16 v[22:25], v[12:15], v[76:79], v[22:25]
    v_and_b32 v14, v43, v26
    v_and_b32 v15, v43, v27
    s_waitcnt vmcnt(21)
    v_mfma_f32_16x16x32_bf16 v[18:21], v[10:13], v[80:83], v[18:21]
    v_mfma_f32_16x16x32_bf16 v[22:25], v[8:11], v[80:83], v[22:25]
    v_lshlrev_b32 v28, 5, v0
    s_lshl_b32 s59, s60, 11
    v_add_u32 v28, s59, v28
    v_mov_b32 v29, 1
    s_lshl_b32 s61, s6, 20
    s_mul_i32 s59, s4, 90112
    s_add_u32 s61, s61, s59
    s_lshl_b32 s59, s60, 14
    s_add_u32 s61, s61, s59
    s_lshl_b32 s59, s5, 6
    s_add_u32 s61, s61, s59
    s_add_u32 s61, s61, 24576
    v_lshlrev_b32 v30, 4, v0
    s_lshl_b32 s59, s60, 9
    v_add_u32 v30, s59, v30
    v_lshrrev_b32 v31, 2, v0
    v_lshlrev_b32 v31, 11, v31
    v_lshl_add_u32 v31, v4, 4, v31
    v_and_b32 v10, v44, v26
    v_and_b32 v11, v44, v27
    s_waitcnt vmcnt(20)
    v_mfma_f32_16x16x32_bf16 v[18:21], v[14:17], v[84:87], v[18:21]
    v_mfma_f32_16x16x32_bf16 v[22:25], v[12:15], v[84:87], v[22:25]
    v_and_b32 v14, v45, v26
    v_and_b32 v15, v45, v27
    s_waitcnt vmcnt(19)
    v_mfma_f32_16x16x32_bf16 v[18:21], v[10:13], v[88:91], v[18:21]
    v_mfma_f32_16x16x32_bf16 v[22:25], v[8:11], v[88:91], v[22:25]
    v_and_b32 v10, v46, v26
    v_and_b32 v11, v46, v27
    s_waitcnt vmcnt(18)
    v_mfma_f32_16x16x32_bf16 v[18:21], v[14:17], v[92:95], v[18:21]
    v_mfma_f32_16x16x32_bf16 v[22:25], v[12:15], v[92:95], v[22:25]
    v_and_b32 v14, v47, v26
    v_and_b32 v15, v47, v27
    s_waitcnt vmcnt(17)
    v_mfma_f32_16x16x32_bf16 v[18:21], v[10:13], v[96:99], v[18:21]
    v_mfma_f32_16x16x32_bf16 v[22:25], v[8:11], v[96:99], v[22:25]
    v_and_b32 v10, v48, v26
    v_and_b32 v11, v48, v27
    s_waitcnt vmcnt(16)
    v_mfma_f32_16x16x32_bf16 v[18:21], v[14:17], v[100:103], v[18:21]
    v_mfma_f32_16x16x32_bf16 v[22:25], v[12:15], v[100:103], v[22:25]
    v_and_b32 v14, v49, v26
    v_and_b32 v15, v49, v27
    s_waitcnt vmcnt(15)
    v_mfma_f32_16x16x32_bf16 v[18:21], v[10:13], v[104:107], v[18:21]
    v_mfma_f32_16x16x32_bf16 v[22:25], v[8:11], v[104:107], v[22:25]
    v_and_b32 v10, v50, v26
    v_and_b32 v11, v50, v27
    s_waitcnt vmcnt(14)
    v_mfma_f32_16x16x32_bf16 v[18:21], v[14:17], v[108:111], v[18:21]
    v_mfma_f32_16x16x32_bf16 v[22:25], v[12:15], v[108:111], v[22:25]
    v_and_b32 v14, v51, v26
    v_and_b32 v15, v51, v27
    s_waitcnt vmcnt(13)
    v_mfma_f32_16x16x32_bf16 v[18:21], v[10:13], v[112:115], v[18:21]
    v_mfma_f32_16x16x32_bf16 v[22:25], v[8:11], v[112:115], v[22:25]
    v_and_b32 v10, v52, v26
    v_and_b32 v11, v52, v27
    s_waitcnt vmcnt(12)
    v_mfma_f32_16x16x32_bf16 v[18:21], v[14:17], v[116:119], v[18:21]
    v_mfma_f32_16x16x32_bf16 v[22:25], v[12:15], v[116:119], v[22:25]
    v_and_b32 v14, v53, v26
    v_and_b32 v15, v53, v27
    s_waitcnt vmcnt(11)
    v_mfma_f32_16x16x32_bf16 v[18:21], v[10:13], v[120:123], v[18:21]
    v_mfma_f32_16x16x32_bf16 v[22:25], v[8:11], v[120:123], v[22:25]
    v_and_b32 v10, v54, v26
    v_and_b32 v11, v54, v27
    s_waitcnt vmcnt(10)
    v_mfma_f32_16x16x32_bf16 v[18:21], v[14:17], v[124:127], v[18:21]
    v_mfma_f32_16x16x32_bf16 v[22:25], v[12:15], v[124:127], v[22:25]
    v_and_b32 v14, v55, v26
    v_and_b32 v15, v55, v27
    s_waitcnt vmcnt(9)
    v_mfma_f32_16x16x32_bf16 v[18:21], v[10:13], v[128:131], v[18:21]
    v_mfma_f32_16x16x32_bf16 v[22:25], v[8:11], v[128:131], v[22:25]
    v_and_b32 v10, v56, v26
    v_and_b32 v11, v56, v27
    s_waitcnt vmcnt(8)
    v_mfma_f32_16x16x32_bf16 v[18:21], v[14:17], v[132:135], v[18:21]
    v_mfma_f32_16x16x32_bf16 v[22:25], v[12:15], v[132:135], v[22:25]
    v_and_b32 v14, v57, v26
    v_and_b32 v15, v57, v27
    s_waitcnt vmcnt(7)
    v_mfma_f32_16x16x32_bf16 v[18:21], v[10:13], v[136:139], v[18:21]
    v_mfma_f32_16x16x32_bf16 v[22:25], v[8:11], v[136:139], v[22:25]
    v_and_b32 v10, v58, v26
    v_and_b32 v11, v58, v27
    s_waitcnt vmcnt(6)
    v_mfma_f32_16x16x32_bf16 v[18:21], v[14:17], v[140:143], v[18:21]
    v_mfma_f32_16x16x32_bf16 v[22:25], v[12:15], v[140:143], v[22:25]
    v_and_b32 v14, v59, v26
    v_and_b32 v15, v59, v27
    s_waitcnt vmcnt(5)
    v_mfma_f32_16x16x32_bf16 v[18:21], v[10:13], v[144:147], v[18:21]
    v_mfma_f32_16x16x32_bf16 v[22:25], v[8:11], v[144:147], v[22:25]
    v_and_b32 v10, v60, v26
    v_and_b32 v11, v60, v27
    s_waitcnt vmcnt(4)
    v_mfma_f32_16x16x32_bf16 v[18:21], v[14:17], v[148:151], v[18:21]
    v_mfma_f32_16x16x32_bf16 v[22:25], v[12:15], v[148:151], v[22:25]
    v_and_b32 v14, v61, v26
    v_and_b32 v15, v61, v27
    s_waitcnt vmcnt(3)
    v_mfma_f32_16x16x32_bf16 v[18:21], v[10:13], v[152:155], v[18:21]
    v_mfma_f32_16x16x32_bf16 v[22:25], v[8:11], v[152:155], v[22:25]
    v_and_b32 v10, v62, v26
    v_and_b32 v11, v62, v27
    s_waitcnt vmcnt(2)
    v_mfma_f32_16x16x32_bf16 v[18:21], v[14:17], v[156:159], v[18:21]
    v_mfma_f32_16x16x32_bf16 v[22:25], v[12:15], v[156:159], v[22:25]
    v_and_b32 v14, v63, v26
    v_and_b32 v15, v63, v27
    s_waitcnt vmcnt(1)
    v_mfma_f32_16x16x32_bf16 v[18:21], v[10:13], v[160:163], v[18:21]
    v_mfma_f32_16x16x32_bf16 v[22:25], v[8:11], v[160:163], v[22:25]
    s_nop 1
    s_waitcnt vmcnt(0)
    v_mfma_f32_16x16x32_bf16 v[18:21], v[14:17], v[164:167], v[18:21]
    v_mfma_f32_16x16x32_bf16 v[22:25], v[12:15], v[164:167], v[22:25]
    s_branch L_pv_done
L_vp_12:
    ds_read_b32 v39, v5 offset:0
    ds_read_b128 v[28:31], v37 offset:2560
    ds_read_b128 v[32:35], v37 offset:2576
    s_waitcnt vmcnt(7)
    buffer_load_dwordx4 v[88:91], v6, s[8:11], s58 offen nt
    s_add_u32 s58, s58, 4096
    s_waitcnt vmcnt(7)
    buffer_load_dwordx4 v[92:95], v6, s[8:11], s58 offen nt
    s_add_u32 s58, s58, 4096
    s_waitcnt vmcnt(7)
    buffer_load_dwordx4 v[96:99], v6, s[8:11], s58 offen nt
    s_add_u32 s58, s58, 4096
    s_waitcnt vmcnt(7)
    buffer_load_dwordx4 v[100:103], v6, s[8:11], s58 offen nt
    s_add_u32 s58, s58, 4096
    s_waitcnt lgkmcnt(0)
    v_readfirstlane_b32 s6, v39
    v_and_b32 v10, v28, v26
    v_and_b32 v11, v28, v27
    v_and_b32 v14, v29, v26
    v_and_b32 v15, v29, v27
    s_waitcnt vmcnt(15)
    v_mfma_f32_16x16x32_bf16 v[18:21], v[10:13], v[40:43], v[18:21]
    v_mfma_f32_16x16x32_bf16 v[22:25], v[8:11], v[40:43], v[22:25]
    v_and_b32 v10, v30, v26
    v_and_b32 v11, v30, v27
    s_waitcnt vmcnt(14)
    v_mfma_f32_16x16x32_bf16 v[18:21], v[14:17], v[44:47], v[18:21]
    v_mfma_f32_16x16x32_bf16 v[22:25], v[12:15], v[44:47], v[22:25]
    v_and_b32 v14, v31, v26
    v_and_b32 v15, v31, v27
    s_waitcnt vmcnt(7)
    buffer_load_dwordx4 v[104:107], v6, s[8:11], s58 offen nt
    s_add_u32 s58, s58, 4096
    s_waitcnt vmcnt(14)
    v_mfma_f32_16x16x32_bf16 v[18:21], v[10:13], v[48:51], v[18:21]
    v_mfma_f32_16x16x32_bf16 v[22:25], v[8:11], v[48:51], v[22:25]
    v_and_b32 v10, v32, v26
    v_and_b32 v11, v32, v27
    s_waitcnt vmcnt(13)
    v_mfma_f32_16x16x32_bf16 v[18:21], v[14:17], v[52:55], v[18:21]
    v_mfma_f32_16x16x32_bf16 v[22:25], v[12:15], v[52:55], v[22:25]
    v_and_b32 v14, v33, v26
    v_and_b32 v15, v33, v27
    s_waitcnt vmcnt(7)
    buffer_load_dwordx4 v[108:111], v6, s[8:11], s58 offen nt
    s_add_u32 s58, s58, 4096
    s_waitcnt vmcnt(13)
    v_mfma_f32_16x16x32_bf16 v[18:21], v[10:13], v[56:59], v[18:21]
    v_mfma_f32_16x16x32_bf16 v[22:25], v[8:11], v[56:59], v[22:25]
    v_and_b32 v10, v34, v26
    v_and_b32 v11, v34, v27
    s_waitcnt vmcnt(12)
    v_mfma_f32_16x16x32_bf16 v[18:21], v[14:17], v[60:63], v[18:21]
    v_mfma_f32_16x16x32_bf16 v[22:25], v[12:15], v[60:63], v[22:25]
    v_and_b32 v14, v35, v26
    v_and_b32 v15, v35, v27
    s_waitcnt vmcnt(7)
    buffer_load_dwordx4 v[112:115], v6, s[8:11], s58 offen nt
    s_add_u32 s58, s58, 4096
    s_waitcnt vmcnt(12)
    v_mfma_f32_16x16x32_bf16 v[18:21], v[10:13], v[64:67], v[18:21]
    v_mfma_f32_16x16x32_bf16 v[22:25], v[8:11], v[64:67], v[22:25]
    ds_read_b128 v[40:43], v37 offset:2592
    ds_read_b128 v[44:47], v37 offset:2608
    ds_read_b128 v[48:51], v37 offset:2624
    ds_read_b128 v[52:55], v37 offset:2640
    ds_read_b128 v[56:59], v37 offset:2656
    ds_read_b128 v[60:63], v37 offset:2672
    s_waitcnt lgkmcnt(0)
    v_and_b32 v10, v40, v26
    v_and_b32 v11, v40, v27
    s_waitcnt vmcnt(11)
    v_mfma_f32_16x16x32_bf16 v[18:21], v[14:17], v[68:71], v[18:21]
    v_mfma_f32_16x16x32_bf16 v[22:25], v[12:15], v[68:71], v[22:25]
    v_and_b32 v14, v41, v26
    v_and_b32 v15, v41, v27
    s_waitcnt vmcnt(7)
    buffer_load_dwordx4 v[116:119], v6, s[8:11], s58 offen nt
    s_add_u32 s58, s58, 4096
    s_waitcnt vmcnt(11)
    v_mfma_f32_16x16x32_bf16 v[18:21], v[10:13], v[72:75], v[18:21]
    v_mfma_f32_16x16x32_bf16 v[22:25], v[8:11], v[72:75], v[22:25]
    v_and_b32 v10, v42, v26
    v_and_b32 v11, v42, v27
    s_waitcnt vmcnt(10)
    v_mfma_f32_16x16x32_bf16 v[18:21], v[14:17], v[76:79], v[18:21]
    v_mfma_f32_16x16x32_bf16 v[22:25], v[12:15], v[76:79], v[22:25]
    v_and_b32 v14, v43, v26
    v_and_b32 v15, v43, v27
    s_waitcnt vmcnt(7)
    buffer_load_dwordx4 v[120:123], v6, s[8:11], s58 offen nt
    s_add_u32 s58, s58, 4096
    s_waitcnt vmcnt(10)
    v_mfma_f32_16x16x32_bf16 v[18:21], v[10:13], v[80:83], v[18:21]
    v_mfma_f32_16x16x32_bf16 v[22:25], v[8:11], v[80:83], v[22:25]
    v_lshlrev_b32 v28, 5, v0
    s_lshl_b32 s59, s60, 11
    v_add_u32 v28, s59, v28
    v_mov_b32 v29, 1
    s_lshl_b32 s61, s6, 20
    s_mul_i32 s59, s4, 90112
    s_add_u32 s61, s61, s59
    s_lshl_b32 s59, s60, 14
    s_add_u32 s61, s61, s59
    s_lshl_b32 s59, s5, 6
    s_add_u32 s61, s61, s59
    s_add_u32 s61, s61, 24576
    v_lshlrev_b32 v30, 4, v0
    s_lshl_b32 s59, s60, 9
    v_add_u32 v30, s59, v30
    v_lshrrev_b32 v31, 2, v0
    v_lshlrev_b32 v31, 11, v31
    v_lshl_add_u32 v31, v4, 4, v31
    v_and_b32 v10, v44, v26
    v_and_b32 v11, v44, v27
    s_waitcnt vmcnt(9)
    v_mfma_f32_16x16x32_bf16 v[18:21], v[14:17], v[84:87], v[18:21]
    v_mfma_f32_16x16x32_bf16 v[22:25], v[12:15], v[84:87], v[22:25]
    v_and_b32 v14, v45, v26
    v_and_b32 v15, v45, v27
    s_waitcnt vmcnt(7)
    buffer_load_dwordx4 v[124:127], v6, s[8:11], s58 offen nt
    s_add_u32 s58, s58, 4096
    s_waitcnt vmcnt(9)
    v_mfma_f32_16x16x32_bf16 v[18:21], v[10:13], v[88:91], v[18:21]
    v_mfma_f32_16x16x32_bf16 v[22:25], v[8:11], v[88:91], v[22:25]
    v_and_b32 v10, v46, v26
    v_and_b32 v11, v46, v27
    s_waitcnt vmcnt(8)
    v_mfma_f32_16x16x32_bf16 v[18:21], v[14:17], v[92:95], v[18:21]
    v_mfma_f32_16x16x32_bf16 v[22:25], v[12:15], v[92:95], v[22:25]
    v_and_b32 v14, v47, v26
    v_and_b32 v15, v47, v27
    s_waitcnt vmcnt(7)
    buffer_load_dwordx4 v[128:131], v6, s[8:11], s58 offen nt
    s_add_u32 s58, s58, 4096
    s_waitcnt vmcnt(8)
    v_mfma_f32_16x16x32_bf16 v[18:21], v[10:13], v[96:99], v[18:21]
    v_mfma_f32_16x16x32_bf16 v[22:25], v[8:11], v[96:99], v[22:25]
    v_and_b32 v10, v48, v26
    v_and_b32 v11, v48, v27
    s_waitcnt vmcnt(7)
    buffer_load_dwordx4 v[132:135], v6, s[8:11], s58 offen nt
    s_add_u32 s58, s58, 4096
    s_waitcnt vmcnt(8)
    v_mfma_f32_16x16x32_bf16 v[18:21], v[14:17], v[100:103], v[18:21]
    v_mfma_f32_16x16x32_bf16 v[22:25], v[12:15], v[100:103], v[22:25]
    v_and_b32 v14, v49, v26
    v_and_b32 v15, v49, v27
    s_waitcnt vmcnt(7)
    buffer_load_dwordx4 v[136:139], v6, s[8:11], s58 offen nt
    s_add_u32 s58, s58, 4096
    s_waitcnt vmcnt(8)
    v_mfma_f32_16x16x32_bf16 v[18:21], v[10:13], v[104:107], v[18:21]
    v_mfma_f32_16x16x32_bf16 v[22:25], v[8:11], v[104:107], v[22:25]
    v_and_b32 v10, v50, v26
    v_and_b32 v11, v50, v27
    s_waitcnt vmcnt(7)
    buffer_load_dwordx4 v[140:143], v6, s[8:11], s58 offen nt
    s_add_u32 s58, s58, 4096
    s_waitcnt vmcnt(8)
    v_mfma_f32_16x16x32_bf16 v[18:21], v[14:17], v[108:111], v[18:21]
    v_mfma_f32_16x16x32_bf16 v[22:25], v[12:15], v[108:111], v[22:25]
    v_and_b32 v14, v51, v26
    v_and_b32 v15, v51, v27
    s_waitcnt vmcnt(7)
    buffer_load_dwordx4 v[144:147], v6, s[8:11], s58 offen nt
    s_add_u32 s58, s58, 4096
    s_waitcnt vmcnt(8)
    v_mfma_f32_16x16x32_bf16 v[18:21], v[10:13], v[112:115], v[18:21]
    v_mfma_f32_16x16x32_bf16 v[22:25], v[8:11], v[112:115], v[22:25]
    v_and_b32 v10, v52, v26
    v_and_b32 v11, v52, v27
    s_waitcnt vmcnt(7)
    buffer_load_dwordx4 v[148:151], v6, s[8:11], s58 offen nt
    s_add_u32 s58, s58, 4096
    s_waitcnt vmcnt(8)
    v_mfma_f32_16x16x32_bf16 v[18:21], v[14:17], v[116:119], v[18:21]
    v_mfma_f32_16x16x32_bf16 v[22:25], v[12:15], v[116:119], v[22:25]
    v_and_b32 v14, v53, v26
    v_and_b32 v15, v53, v27
    s_waitcnt vmcnt(7)
    buffer_load_dwordx4 v[152:155], v6, s[8:11], s58 offen nt
    s_add_u32 s58, s58, 4096
    s_waitcnt vmcnt(8)
    v_mfma_f32_16x16x32_bf16 v[18:21], v[10:13], v[120:123], v[18:21]
    v_mfma_f32_16x16x32_bf16 v[22:25], v[8:11], v[120:123], v[22:25]
    v_and_b32 v10, v54, v26
    v_and_b32 v11, v54, v27
    s_waitcnt vmcnt(7)
    buffer_load_dwordx4 v[156:159], v6, s[8:11], s58 offen nt
    s_add_u32 s58, s58, 4096
    s_waitcnt vmcnt(8)
    v_mfma_f32_16x16x32_bf16 v[18:21], v[14:17], v[124:127], v[18:21]
    v_mfma_f32_16x16x32_bf16 v[22:25], v[12:15], v[124:127], v[22:25]
    v_and_b32 v14, v55, v26
    v_and_b32 v15, v55, v27
    s_waitcnt vmcnt(7)
    buffer_load_dwordx4 v[160:163], v6, s[8:11], s58 offen nt
    s_add_u32 s58, s58, 4096
    s_waitcnt vmcnt(8)
    v_mfma_f32_16x16x32_bf16 v[18:21], v[10:13], v[128:131], v[18:21]
    v_mfma_f32_16x16x32_bf16 v[22:25], v[8:11], v[128:131], v[22:25]
    v_and_b32 v10, v56, v26
    v_and_b32 v11, v56, v27
    s_waitcnt vmcnt(7)
    buffer_load_dwordx4 v[164:167], v6, s[8:11], s58 offen nt
    s_add_u32 s58, s58, 4096
    v_mov_b32 v7, 1
    s_mov_b64 exec, 1
    ds_add_u32 v5, v7 offset:12
    s_mov_b64 exec, -1
    s_waitcnt vmcnt(8)
    v_mfma_f32_16x16x32_bf16 v[18:21], v[14:17], v[132:135], v[18:21]
    v_mfma_f32_16x16x32_bf16 v[22:25], v[12:15], v[132:135], v[22:25]
    v_and_b32 v14, v57, v26
    v_and_b32 v15, v57, v27
    s_waitcnt vmcnt(7)
    v_mfma_f32_16x16x32_bf16 v[18:21], v[10:13], v[136:139], v[18:21]
    v_mfma_f32_16x16x32_bf16 v[22:25], v[8:11], v[136:139], v[22:25]
    v_and_b32 v10, v58, v26
    v_and_b32 v11, v58, v27
    s_waitcnt vmcnt(6)
    v_mfma_f32_16x16x32_bf16 v[18:21], v[14:17], v[140:143], v[18:21]
    v_mfma_f32_16x16x32_bf16 v[22:25], v[12:15], v[140:143], v[22:25]
    v_and_b32 v14, v59, v26
    v_and_b32 v15, v59, v27
    s_waitcnt vmcnt(5)
    v_mfma_f32_16x16x32_bf16 v[18:21], v[10:13], v[144:147], v[18:21]
    v_mfma_f32_16x16x32_bf16 v[22:25], v[8:11], v[144:147], v[22:25]
    v_and_b32 v10, v60, v26
    v_and_b32 v11, v60, v27
    s_waitcnt vmcnt(4)
    v_mfma_f32_16x16x32_bf16 v[18:21], v[14:17], v[148:151], v[18:21]
    v_mfma_f32_16x16x32_bf16 v[22:25], v[12:15], v[148:151], v[22:25]
    v_and_b32 v14, v61, v26
    v_and_b32 v15, v61, v27
    s_waitcnt vmcnt(3)
    v_mfma_f32_16x16x32_bf16 v[18:21], v[10:13], v[152:155], v[18:21]
    v_mfma_f32_16x16x32_bf16 v[22:25], v[8:11], v[152:155], v[22:25]
    v_and_b32 v10, v62, v26
    v_and_b32 v11, v62, v27
    s_waitcnt vmcnt(2)
    v_mfma_f32_16x16x32_bf16 v[18:21], v[14:17], v[156:159], v[18:21]
    v_mfma_f32_16x16x32_bf16 v[22:25], v[12:15], v[156:159], v[22:25]
    v_and_b32 v14, v63, v26
    v_and_b32 v15, v63, v27
    s_waitcnt vmcnt(1)
    v_mfma_f32_16x16x32_bf16 v[18:21], v[10:13], v[160:163], v[18:21]
    v_mfma_f32_16x16x32_bf16 v[22:25], v[8:11], v[160:163], v[22:25]
    s_nop 1
    s_waitcnt vmcnt(0)
    v_mfma_f32_16x16x32_bf16 v[18:21], v[14:17], v[164:167], v[18:21]
    v_mfma_f32_16x16x32_bf16 v[22:25], v[12:15], v[164:167], v[22:25]
    s_branch L_pv_done
L_vp_16:
    ds_read_b32 v39, v5 offset:0
    ds_read_b128 v[28:31], v37 offset:2560
    ds_read_b128 v[32:35], v37 offset:2576
    s_waitcnt vmcnt(7)
    buffer_load_dwordx4 v[104:107], v6, s[8:11], s58 offen nt
    s_add_u32 s58, s58, 4096
    s_waitcnt vmcnt(7)
    buffer_load_dwordx4 v[108:111], v6, s[8:11], s58 offen nt
    s_add_u32 s58, s58, 4096
    s_waitcnt vmcnt(7)
    buffer_load_dwordx4 v[112:115], v6, s[8:11], s58 offen nt
    s_add_u32 s58, s58, 4096
    s_waitcnt vmcnt(7)
    buffer_load_dwordx4 v[116:119], v6, s[8:11], s58 offen nt
    s_add_u32 s58, s58, 4096
    s_waitcnt lgkmcnt(0)
    v_readfirstlane_b32 s6, v39
    v_and_b32 v10, v28, v26
    v_and_b32 v11, v28, v27
    v_and_b32 v14, v29, v26
    v_and_b32 v15, v29, v27
    s_waitcnt vmcnt(19)
    v_mfma_f32_16x16x32_bf16 v[18:21], v[10:13], v[40:43], v[18:21]
    v_mfma_f32_16x16x32_bf16 v[22:25], v[8:11], v[40:43], v[22:25]
    v_and_b32 v10, v30, v26
    v_and_b32 v11, v30, v27
    s_waitcnt vmcnt(18)
    v_mfma_f32_16x16x32_bf16 v[18:21], v[14:17], v[44:47], v[18:21]
    v_mfma_f32_16x16x32_bf16 v[22:25], v[12:15], v[44:47], v[22:25]
    v_and_b32 v14, v31, v26
    v_and_b32 v15, v31, v27
    s_waitcnt vmcnt(7)
    buffer_load_dwordx4 v[120:123], v6, s[8:11], s58 offen nt
    s_add_u32 s58, s58, 4096
    s_waitcnt vmcnt(18)
    v_mfma_f32_16x16x32_bf16 v[18:21], v[10:13], v[48:51], v[18:21]
    v_mfma_f32_16x16x32_bf16 v[22:25], v[8:11], v[48:51], v[22:25]
    v_and_b32 v10, v32, v26
    v_and_b32 v11, v32, v27
    s_waitcnt vmcnt(17)
    v_mfma_f32_16x16x32_bf16 v[18:21], v[14:17], v[52:55], v[18:21]
    v_mfma_f32_16x16x32_bf16 v[22:25], v[12:15], v[52:55], v[22:25]
    v_and_b32 v14, v33, v26
    v_and_b32 v15, v33, v27
    s_waitcnt vmcnt(7)
    buffer_load_dwordx4 v[124:127], v6, s[8:11], s58 offen nt
    s_add_u32 s58, s58, 4096
    s_waitcnt vmcnt(17)
    v_mfma_f32_16x16x32_bf16 v[18:21], v[10:13], v[56:59], v[18:21]
    v_mfma_f32_16x16x32_bf16 v[22:25], v[8:11], v[56:59], v[22:25]
    v_and_b32 v10, v34, v26
    v_and_b32 v11, v34, v27
    s_waitcnt vmcnt(16)
    v_mfma_f32_16x16x32_bf16 v[18:21], v[14:17], v[60:63], v[18:21]
    v_mfma_f32_16x16x32_bf16 v[22:25], v[12:15], v[60:63], v[22:25]
    v_and_b32 v14, v35, v26
    v_and_b32 v15, v35, v27
    s_waitcnt vmcnt(7)
    buffer_load_dwordx4 v[128:131], v6, s[8:11], s58 offen nt
    s_add_u32 s58, s58, 4096
    s_waitcnt vmcnt(16)
    v_mfma_f32_16x16x32_bf16 v[18:21], v[10:13], v[64:67], v[18:21]
    v_mfma_f32_16x16x32_bf16 v[22:25], v[8:11], v[64:67], v[22:25]
    ds_read_b128 v[40:43], v37 offset:2592
    ds_read_b128 v[44:47], v37 offset:2608
    ds_read_b128 v[48:51], v37 offset:2624
    ds_read_b128 v[52:55], v37 offset:2640
    ds_read_b128 v[56:59], v37 offset:2656
    ds_read_b128 v[60:63], v37 offset:2672
    s_waitcnt lgkmcnt(0)
    v_and_b32 v10, v40, v26
    v_and_b32 v11, v40, v27
    s_waitcnt vmcnt(15)
    v_mfma_f32_16x16x32_bf16 v[18:21], v[14:17], v[68:71], v[18:21]
    v_mfma_f32_16x16x32_bf16 v[22:25], v[12:15], v[68:71], v[22:25]
    v_and_b32 v14, v41, v26
    v_and_b32 v15, v41, v27
    s_waitcnt vmcnt(7)
    buffer_load_dwordx4 v[132:135], v6, s[8:11], s58 offen nt
    s_add_u32 s58, s58, 4096
    s_waitcnt vmcnt(15)
    v_mfma_f32_16x16x32_bf16 v[18:21], v[10:13], v[72:75], v[18:21]
    v_mfma_f32_16x16x32_bf16 v[22:25], v[8:11], v[72:75], v[22:25]
    v_and_b32 v10, v42, v26
    v_and_b32 v11, v42, v27
    s_waitcnt vmcnt(14)
    v_mfma_f32_16x16x32_bf16 v[18:21], v[14:17], v[76:79], v[18:21]
    v_mfma_f32_16x16x32_bf16 v[22:25], v[12:15], v[76:79], v[22:25]
    v_and_b32 v14, v43, v26
    v_and_b32 v15, v43, v27
    s_waitcnt vmcnt(7)
    buffer_load_dwordx4 v[136:139], v6, s[8:11], s58 offen nt
    s_add_u32 s58, s58, 4096
    s_waitcnt vmcnt(14)
    v_mfma_f32_16x16x32_bf16 v[18:21], v[10:13], v[80:83], v[18:21]
    v_mfma_f32_16x16x32_bf16 v[22:25], v[8:11], v[80:83], v[22:25]
    v_lshlrev_b32 v28, 5, v0
    s_lshl_b32 s59, s60, 11
    v_add_u32 v28, s59, v28
    v_mov_b32 v29, 1
    s_lshl_b32 s61, s6, 20
    s_mul_i32 s59, s4, 90112
    s_add_u32 s61, s61, s59
    s_lshl_b32 s59, s60, 14
    s_add_u32 s61, s61, s59
    s_lshl_b32 s59, s5, 6
    s_add_u32 s61, s61, s59
    s_add_u32 s61, s61, 24576
    v_lshlrev_b32 v30, 4, v0
    s_lshl_b32 s59, s60, 9
    v_add_u32 v30, s59, v30
    v_lshrrev_b32 v31, 2, v0
    v_lshlrev_b32 v31, 11, v31
    v_lshl_add_u32 v31, v4, 4, v31
    v_and_b32 v10, v44, v26
    v_and_b32 v11, v44, v27
    s_waitcnt vmcnt(13)
    v_mfma_f32_16x16x32_bf16 v[18:21], v[14:17], v[84:87], v[18:21]
    v_mfma_f32_16x16x32_bf16 v[22:25], v[12:15], v[84:87], v[22:25]
    v_and_b32 v14, v45, v26
    v_and_b32 v15, v45, v27
    s_waitcnt vmcnt(7)
    buffer_load_dwordx4 v[140:143], v6, s[8:11], s58 offen nt
    s_add_u32 s58, s58, 4096
    s_waitcnt vmcnt(13)
    v_mfma_f32_16x16x32_bf16 v[18:21], v[10:13], v[88:91], v[18:21]
    v_mfma_f32_16x16x32_bf16 v[22:25], v[8:11], v[88:91], v[22:25]
    v_and_b32 v10, v46, v26
    v_and_b32 v11, v46, v27
    s_waitcnt vmcnt(12)
    v_mfma_f32_16x16x32_bf16 v[18:21], v[14:17], v[92:95], v[18:21]
    v_mfma_f32_16x16x32_bf16 v[22:25], v[12:15], v[92:95], v[22:25]
    v_and_b32 v14, v47, v26
    v_and_b32 v15, v47, v27
    s_waitcnt vmcnt(7)
    buffer_load_dwordx4 v[144:147], v6, s[8:11], s58 offen nt
    s_add_u32 s58, s58, 4096
    s_waitcnt vmcnt(12)
    v_mfma_f32_16x16x32_bf16 v[18:21], v[10:13], v[96:99], v[18:21]
    v_mfma_f32_16x16x32_bf16 v[22:25], v[8:11], v[96:99], v[22:25]
    v_and_b32 v10, v48, v26
    v_and_b32 v11, v48, v27
    s_waitcnt vmcnt(11)
    v_mfma_f32_16x16x32_bf16 v[18:21], v[14:17], v[100:103], v[18:21]
    v_mfma_f32_16x16x32_bf16 v[22:25], v[12:15], v[100:103], v[22:25]
    v_and_b32 v14, v49, v26
    v_and_b32 v15, v49, v27
    s_waitcnt vmcnt(7)
    buffer_load_dwordx4 v[148:151], v6, s[8:11], s58 offen nt
    s_add_u32 s58, s58, 4096
    s_waitcnt vmcnt(11)
    v_mfma_f32_16x16x32_bf16 v[18:21], v[10:13], v[104:107], v[18:21]
    v_mfma_f32_16x16x32_bf16 v[22:25], v[8:11], v[104:107], v[22:25]
    v_and_b32 v10, v50, v26
    v_and_b32 v11, v50, v27
    s_waitcnt vmcnt(10)
    v_mfma_f32_16x16x32_bf16 v[18:21], v[14:17], v[108:111], v[18:21]
    v_mfma_f32_16x16x32_bf16 v[22:25], v[12:15], v[108:111], v[22:25]
    v_and_b32 v14, v51, v26
    v_and_b32 v15, v51, v27
    s_waitcnt vmcnt(7)
    buffer_load_dwordx4 v[152:155], v6, s[8:11], s58 offen nt
    s_add_u32 s58, s58, 4096
    s_waitcnt vmcnt(10)
    v_mfma_f32_16x16x32_bf16 v[18:21], v[10:13], v[112:115], v[18:21]
    v_mfma_f32_16x16x32_bf16 v[22:25], v[8:11], v[112:115], v[22:25]
    v_and_b32 v10, v52, v26
    v_and_b32 v11, v52, v27
    s_waitcnt vmcnt(9)
    v_mfma_f32_16x16x32_bf16 v[18:21], v[14:17], v[116:119], v[18:21]
    v_mfma_f32_16x16x32_bf16 v[22:25], v[12:15], v[116:119], v[22:25]
    v_and_b32 v14, v53, v26
    v_and_b32 v15, v53, v27
    s_waitcnt vmcnt(7)
    buffer_load_dwordx4 v[156:159], v6, s[8:11], s58 offen nt
    s_add_u32 s58, s58, 4096
    s_waitcnt vmcnt(9)
    v_mfma_f32_16x16x32_bf16 v[18:21], v[10:13], v[120:123], v[18:21]
    v_mfma_f32_16x16x32_bf16 v[22:25], v[8:11], v[120:123], v[22:25]
    v_and_b32 v10, v54, v26
    v_and_b32 v11, v54, v27
    s_waitcnt vmcnt(8)
    v_mfma_f32_16x16x32_bf16 v[18:21], v[14:17], v[124:127], v[18:21]
    v_mfma_f32_16x16x32_bf16 v[22:25], v[12:15], v[124:127], v[22:25]
    v_and_b32 v14, v55, v26
    v_and_b32 v15, v55, v27
    s_waitcnt vmcnt(7)
    buffer_load_dwordx4 v[160:163], v6, s[8:11], s58 offen nt
    s_add_u32 s58, s58, 4096
    s_waitcnt vmcnt(8)
    v_mfma_f32_16x16x32_bf16 v[18:21], v[10:13], v[128:131], v[18:21]
    v_mfma_f32_16x16x32_bf16 v[22:25], v[8:11], v[128:131], v[22:25]
    v_and_b32 v10, v56, v26
    v_and_b32 v11, v56, v27
    s_waitcnt vmcnt(7)
    buffer_load_dwordx4 v[164:167], v6, s[8:11], s58 offen nt
    s_add_u32 s58, s58, 4096
    v_mov_b32 v7, 1
    s_mov_b64 exec, 1
    ds_add_u32 v5, v7 offset:12
    s_mov_b64 exec, -1
    s_waitcnt vmcnt(8)
    v_mfma_f32_16x16x32_bf16 v[18:21], v[14:17], v[132:135], v[18:21]
    v_mfma_f32_16x16x32_bf16 v[22:25], v[12:15], v[132:135], v[22:25]
    v_and_b32 v14, v57, v26
    v_and_b32 v15, v57, v27
    s_waitcnt vmcnt(7)
    v_mfma_f32_16x16x32_bf16 v[18:21], v[10:13], v[136:139], v[18:21]
    v_mfma_f32_16x16x32_bf16 v[22:25], v[8:11], v[136:139], v[22:25]
    v_and_b32 v10, v58, v26
    v_and_b32 v11, v58, v27
    s_waitcnt vmcnt(6)
    v_mfma_f32_16x16x32_bf16 v[18:21], v[14:17], v[140:143], v[18:21]
    v_mfma_f32_16x16x32_bf16 v[22:25], v[12:15], v[140:143], v[22:25]
    v_and_b32 v14, v59, v26
    v_and_b32 v15, v59, v27
    s_waitcnt vmcnt(5)
    v_mfma_f32_16x16x32_bf16 v[18:21], v[10:13], v[144:147], v[18:21]
    v_mfma_f32_16x16x32_bf16 v[22:25], v[8:11], v[144:147], v[22:25]
    v_and_b32 v10, v60, v26
    v_and_b32 v11, v60, v27
    s_waitcnt vmcnt(4)
    v_mfma_f32_16x16x32_bf16 v[18:21], v[14:17], v[148:151], v[18:21]
    v_mfma_f32_16x16x32_bf16 v[22:25], v[12:15], v[148:151], v[22:25]
    v_and_b32 v14, v61, v26
    v_and_b32 v15, v61, v27
    s_waitcnt vmcnt(3)
    v_mfma_f32_16x16x32_bf16 v[18:21], v[10:13], v[152:155], v[18:21]
    v_mfma_f32_16x16x32_bf16 v[22:25], v[8:11], v[152:155], v[22:25]
    v_and_b32 v10, v62, v26
    v_and_b32 v11, v62, v27
    s_waitcnt vmcnt(2)
    v_mfma_f32_16x16x32_bf16 v[18:21], v[14:17], v[156:159], v[18:21]
    v_mfma_f32_16x16x32_bf16 v[22:25], v[12:15], v[156:159], v[22:25]
    v_and_b32 v14, v63, v26
    v_and_b32 v15, v63, v27
    s_waitcnt vmcnt(1)
    v_mfma_f32_16x16x32_bf16 v[18:21], v[10:13], v[160:163], v[18:21]
    v_mfma_f32_16x16x32_bf16 v[22:25], v[8:11], v[160:163], v[22:25]
    s_nop 1
    s_waitcnt vmcnt(0)
    v_mfma_f32_16x16x32_bf16 v[18:21], v[14:17], v[164:167], v[18:21]
    v_mfma_f32_16x16x32_bf16 v[22:25], v[12:15], v[164:167], v[22:25]
    s_branch L_pv_done
L_vp_20:
    ds_read_b32 v39, v5 offset:0
    ds_read_b128 v[28:31], v37 offset:2560
    ds_read_b128 v[32:35], v37 offset:2576
    s_waitcnt vmcnt(7)
    buffer_load_dwordx4 v[120:123], v6, s[8:11], s58 offen nt
    s_add_u32 s58, s58, 4096
    s_waitcnt vmcnt(7)
    buffer_load_dwordx4 v[124:127], v6, s[8:11], s58 offen nt
    s_add_u32 s58, s58, 4096
    s_waitcnt vmcnt(7)
    buffer_load_dwordx4 v[128:131], v6, s[8:11], s58 offen nt
    s_add_u32 s58, s58, 4096
    s_waitcnt vmcnt(7)
    buffer_load_dwordx4 v[132:135], v6, s[8:11], s58 offen nt
    s_add_u32 s58, s58, 4096
    s_waitcnt lgkmcnt(0)
    v_readfirstlane_b32 s6, v39
    v_and_b32 v10, v28, v26
    v_and_b32 v11, v28, v27
    v_and_b32 v14, v29, v26
    v_and_b32 v15, v29, v27
    s_waitcnt vmcnt(23)
    v_mfma_f32_16x16x32_bf16 v[18:21], v[10:13], v[40:43], v[18:21]
    v_mfma_f32_16x16x32_bf16 v[22:25], v[8:11], v[40:43], v[22:25]
    v_and_b32 v10, v30, v26
    v_and_b32 v11, v30, v27
    s_waitcnt vmcnt(22)
    v_mfma_f32_16x16x32_bf16 v[18:21], v[14:17], v[44:47], v[18:21]
    v_mfma_f32_16x16x32_bf16 v[22:25], v[12:15], v[44:47], v[22:25]
    v_and_b32 v14, v31, v26
    v_and_b32 v15, v31, v27
    s_waitcnt vmcnt(7)
    buffer_load_dwordx4 v[136:139], v6, s[8:11], s58 offen nt
    s_add_u32 s58, s58, 4096
    s_waitcnt vmcnt(22)
    v_mfma_f32_16x16x32_bf16 v[18:21], v[10:13], v[48:51], v[18:21]
    v_mfma_f32_16x16x32_bf16 v[22:25], v[8:11], v[48:51], v[22:25]
    v_and_b32 v10, v32, v26
    v_and_b32 v11, v32, v27
    s_waitcnt vmcnt(21)
    v_mfma_f32_16x16x32_bf16 v[18:21], v[14:17], v[52:55], v[18:21]
    v_mfma_f32_16x16x32_bf16 v[22:25], v[12:15], v[52:55], v[22:25]
    v_and_b32 v14, v33, v26
    v_and_b32 v15, v33, v27
    s_waitcnt vmcnt(7)
    buffer_load_dwordx4 v[140:143], v6, s[8:11], s58 offen nt
    s_add_u32 s58, s58, 4096
    s_waitcnt vmcnt(21)
    v_mfma_f32_16x16x32_bf16 v[18:21], v[10:13], v[56:59], v[18:21]
    v_mfma_f32_16x16x32_bf16 v[22:25], v[8:11], v[56:59], v[22:25]
    v_and_b32 v10, v34, v26
    v_and_b32 v11, v34, v27
    s_waitcnt vmcnt(20)
    v_mfma_f32_16x16x32_bf16 v[18:21], v[14:17], v[60:63], v[18:21]
    v_mfma_f32_16x16x32_bf16 v[22:25], v[12:15], v[60:63], v[22:25]
    v_and_b32 v14, v35, v26
    v_and_b32 v15, v35, v27
    s_waitcnt vmcnt(7)
    buffer_load_dwordx4 v[144:147], v6, s[8:11], s58 offen nt
    s_add_u32 s58, s58, 4096
    s_waitcnt vmcnt(20)
    v_mfma_f32_16x16x32_bf16 v[18:21], v[10:13], v[64:67], v[18:21]
    v_mfma_f32_16x16x32_bf16 v[22:25], v[8:11], v[64:67], v[22:25]
    ds_read_b128 v[40:43], v37 offset:2592
    ds_read_b128 v[44:47], v37 offset:2608
    ds_read_b128 v[48:51], v37 offset:2624
    ds_read_b128 v[52:55], v37 offset:2640
    ds_read_b128 v[56:59], v37 offset:2656
    ds_read_b128 v[60:63], v37 offset:2672
    s_waitcnt lgkmcnt(0)
    v_and_b32 v10, v40, v26
    v_and_b32 v11, v40, v27
    s_waitcnt vmcnt(19)
    v_mfma_f32_16x16x32_bf16 v[18:21], v[14:17], v[68:71], v[18:21]
    v_mfma_f32_16x16x32_bf16 v[22:25], v[12:15], v[68:71], v[22:25]
    v_and_b32 v14, v41, v26
    v_and_b32 v15, v41, v27
    s_waitcnt vmcnt(7)
    buffer_load_dwordx4 v[148:151], v6, s[8:11], s58 offen nt
    s_add_u32 s58, s58, 4096
    s_waitcnt vmcnt(19)
    v_mfma_f32_16x16x32_bf16 v[18:21], v[10:13], v[72:75], v[18:21]
    v_mfma_f32_16x16x32_bf16 v[22:25], v[8:11], v[72:75], v[22:25]
    v_and_b32 v10, v42, v26
    v_and_b32 v11, v42, v27
    s_waitcnt vmcnt(18)
    v_mfma_f32_16x16x32_bf16 v[18:21], v[14:17], v[76:79], v[18:21]
    v_mfma_f32_16x16x32_bf16 v[22:25], v[12:15], v[76:79], v[22:25]
    v_and_b32 v14, v43, v26
    v_and_b32 v15, v43, v27
    s_waitcnt vmcnt(7)
    buffer_load_dwordx4 v[152:155], v6, s[8:11], s58 offen nt
    s_add_u32 s58, s58, 4096
    s_waitcnt vmcnt(18)
    v_mfma_f32_16x16x32_bf16 v[18:21], v[10:13], v[80:83], v[18:21]
    v_mfma_f32_16x16x32_bf16 v[22:25], v[8:11], v[80:83], v[22:25]
    v_lshlrev_b32 v28, 5, v0
    s_lshl_b32 s59, s60, 11
    v_add_u32 v28, s59, v28
    v_mov_b32 v29, 1
    s_lshl_b32 s61, s6, 20
    s_mul_i32 s59, s4, 90112
    s_add_u32 s61, s61, s59
    s_lshl_b32 s59, s60, 14
    s_add_u32 s61, s61, s59
    s_lshl_b32 s59, s5, 6
    s_add_u32 s61, s61, s59
    s_add_u32 s61, s61, 24576
    v_lshlrev_b32 v30, 4, v0
    s_lshl_b32 s59, s60, 9
    v_add_u32 v30, s59, v30
    v_lshrrev_b32 v31, 2, v0
    v_lshlrev_b32 v31, 11, v31
    v_lshl_add_u32 v31, v4, 4, v31
    v_and_b32 v10, v44, v26
    v_and_b32 v11, v44, v27
    s_waitcnt vmcnt(17)
    v_mfma_f32_16x16x32_bf16 v[18:21], v[14:17], v[84:87], v[18:21]
    v_mfma_f32_16x16x32_bf16 v[22:25], v[12:15], v[84:87], v[22:25]
    v_and_b32 v14, v45, v26
    v_and_b32 v15, v45, v27
    s_waitcnt vmcnt(7)
    buffer_load_dwordx4 v[156:159], v6, s[8:11], s58 offen nt
    s_add_u32 s58, s58, 4096
    s_waitcnt vmcnt(17)
    v_mfma_f32_16x16x32_bf16 v[18:21], v[10:13], v[88:91], v[18:21]
    v_mfma_f32_16x16x32_bf16 v[22:25], v[8:11], v[88:91], v[22:25]
    v_and_b32 v10, v46, v26
    v_and_b32 v11, v46, v27
    s_waitcnt vmcnt(16)
    v_mfma_f32_16x16x32_bf16 v[18:21], v[14:17], v[92:95], v[18:21]
    v_mfma_f32_16x16x32_bf16 v[22:25], v[12:15], v[92:95], v[22:25]
    v_and_b32 v14, v47, v26
    v_and_b32 v15, v47, v27
    s_waitcnt vmcnt(7)
    buffer_load_dwordx4 v[160:163], v6, s[8:11], s58 offen nt
    s_add_u32 s58, s58, 4096
    s_waitcnt vmcnt(16)
    v_mfma_f32_16x16x32_bf16 v[18:21], v[10:13], v[96:99], v[18:21]
    v_mfma_f32_16x16x32_bf16 v[22:25], v[8:11], v[96:99], v[22:25]
    v_and_b32 v10, v48, v26
    v_and_b32 v11, v48, v27
    s_waitcnt vmcnt(15)
    v_mfma_f32_16x16x32_bf16 v[18:21], v[14:17], v[100:103], v[18:21]
    v_mfma_f32_16x16x32_bf16 v[22:25], v[12:15], v[100:103], v[22:25]
    v_and_b32 v14, v49, v26
    v_and_b32 v15, v49, v27
    s_waitcnt vmcnt(7)
    buffer_load_dwordx4 v[164:167], v6, s[8:11], s58 offen nt
    s_add_u32 s58, s58, 4096
    v_mov_b32 v7, 1
    s_mov_b64 exec, 1
    ds_add_u32 v5, v7 offset:12
    s_mov_b64 exec, -1
    s_waitcnt vmcnt(15)
    v_mfma_f32_16x16x32_bf16 v[18:21], v[10:13], v[104:107], v[18:21]
    v_mfma_f32_16x16x32_bf16 v[22:25], v[8:11], v[104:107], v[22:25]
    v_and_b32 v10, v50, v26
    v_and_b32 v11, v50, v27
    s_waitcnt vmcnt(14)
    v_mfma_f32_16x16x32_bf16 v[18:21], v[14:17], v[108:111], v[18:21]
    v_mfma_f32_16x16x32_bf16 v[22:25], v[12:15], v[108:111], v[22:25]
    v_and_b32 v14, v51, v26
    v_and_b32 v15, v51, v27
    s_waitcnt vmcnt(13)
    v_mfma_f32_16x16x32_bf16 v[18:21], v[10:13], v[112:115], v[18:21]
    v_mfma_f32_16x16x32_bf16 v[22:25], v[8:11], v[112:115], v[22:25]
    v_and_b32 v10, v52, v26
    v_and_b32 v11, v52, v27
    s_waitcnt vmcnt(12)
    v_mfma_f32_16x16x32_bf16 v[18:21], v[14:17], v[116:119], v[18:21]
    v_mfma_f32_16x16x32_bf16 v[22:25], v[12:15], v[116:119], v[22:25]
    v_and_b32 v14, v53, v26
    v_and_b32 v15, v53, v27
    s_waitcnt vmcnt(11)
    v_mfma_f32_16x16x32_bf16 v[18:21], v[10:13], v[120:123], v[18:21]
    v_mfma_f32_16x16x32_bf16 v[22:25], v[8:11], v[120:123], v[22:25]
    v_and_b32 v10, v54, v26
    v_and_b32 v11, v54, v27
    s_waitcnt vmcnt(10)
    v_mfma_f32_16x16x32_bf16 v[18:21], v[14:17], v[124:127], v[18:21]
    v_mfma_f32_16x16x32_bf16 v[22:25], v[12:15], v[124:127], v[22:25]
    v_and_b32 v14, v55, v26
    v_and_b32 v15, v55, v27
    s_waitcnt vmcnt(9)
    v_mfma_f32_16x16x32_bf16 v[18:21], v[10:13], v[128:131], v[18:21]
    v_mfma_f32_16x16x32_bf16 v[22:25], v[8:11], v[128:131], v[22:25]
    v_and_b32 v10, v56, v26
    v_and_b32 v11, v56, v27
    s_waitcnt vmcnt(8)
    v_mfma_f32_16x16x32_bf16 v[18:21], v[14:17], v[132:135], v[18:21]
    v_mfma_f32_16x16x32_bf16 v[22:25], v[12:15], v[132:135], v[22:25]
    v_and_b32 v14, v57, v26
    v_and_b32 v15, v57, v27
    s_waitcnt vmcnt(7)
    v_mfma_f32_16x16x32_bf16 v[18:21], v[10:13], v[136:139], v[18:21]
    v_mfma_f32_16x16x32_bf16 v[22:25], v[8:11], v[136:139], v[22:25]
    v_and_b32 v10, v58, v26
    v_and_b32 v11, v58, v27
    s_waitcnt vmcnt(6)
    v_mfma_f32_16x16x32_bf16 v[18:21], v[14:17], v[140:143], v[18:21]
    v_mfma_f32_16x16x32_bf16 v[22:25], v[12:15], v[140:143], v[22:25]
    v_and_b32 v14, v59, v26
    v_and_b32 v15, v59, v27
    s_waitcnt vmcnt(5)
    v_mfma_f32_16x16x32_bf16 v[18:21], v[10:13], v[144:147], v[18:21]
    v_mfma_f32_16x16x32_bf16 v[22:25], v[8:11], v[144:147], v[22:25]
    v_and_b32 v10, v60, v26
    v_and_b32 v11, v60, v27
    s_waitcnt vmcnt(4)
    v_mfma_f32_16x16x32_bf16 v[18:21], v[14:17], v[148:151], v[18:21]
    v_mfma_f32_16x16x32_bf16 v[22:25], v[12:15], v[148:151], v[22:25]
    v_and_b32 v14, v61, v26
    v_and_b32 v15, v61, v27
    s_waitcnt vmcnt(3)
    v_mfma_f32_16x16x32_bf16 v[18:21], v[10:13], v[152:155], v[18:21]
    v_mfma_f32_16x16x32_bf16 v[22:25], v[8:11], v[152:155], v[22:25]
    v_and_b32 v10, v62, v26
    v_and_b32 v11, v62, v27
    s_waitcnt vmcnt(2)
    v_mfma_f32_16x16x32_bf16 v[18:21], v[14:17], v[156:159], v[18:21]
    v_mfma_f32_16x16x32_bf16 v[22:25], v[12:15], v[156:159], v[22:25]
    v_and_b32 v14, v63, v26
    v_and_b32 v15, v63, v27
    s_waitcnt vmcnt(1)
    v_mfma_f32_16x16x32_bf16 v[18:21], v[10:13], v[160:163], v[18:21]
    v_mfma_f32_16x16x32_bf16 v[22:25], v[8:11], v[160:163], v[22:25]
    s_nop 1
    s_waitcnt vmcnt(0)
    v_mfma_f32_16x16x32_bf16 v[18:21], v[14:17], v[164:167], v[18:21]
    v_mfma_f32_16x16x32_bf16 v[22:25], v[12:15], v[164:167], v[22:25]
    s_branch L_pv_done
L_vp_24:
    ds_read_b32 v39, v5 offset:0
    ds_read_b128 v[28:31], v37 offset:2560
    ds_read_b128 v[32:35], v37 offset:2576
    s_waitcnt vmcnt(7)
    buffer_load_dwordx4 v[136:139], v6, s[8:11], s58 offen nt
    s_add_u32 s58, s58, 4096
    s_waitcnt vmcnt(7)
    buffer_load_dwordx4 v[140:143], v6, s[8:11], s58 offen nt
    s_add_u32 s58, s58, 4096
    s_waitcnt vmcnt(7)
    buffer_load_dwordx4 v[144:147], v6, s[8:11], s58 offen nt
    s_add_u32 s58, s58, 4096
    s_waitcnt vmcnt(7)
    buffer_load_dwordx4 v[148:151], v6, s[8:11], s58 offen nt
    s_add_u32 s58, s58, 4096
    s_waitcnt lgkmcnt(0)
    v_readfirstlane_b32 s6, v39
    v_and_b32 v10, v28, v26
    v_and_b32 v11, v28, v27
    v_and_b32 v14, v29, v26
    v_and_b32 v15, v29, v27
    s_waitcnt vmcnt(27)
    v_mfma_f32_16x16x32_bf16 v[18:21], v[10:13], v[40:43], v[18:21]
    v_mfma_f32_16x16x32_bf16 v[22:25], v[8:11], v[40:43], v[22:25]
    v_and_b32 v10, v30, v26
    v_and_b32 v11, v30, v27
    s_waitcnt vmcnt(26)
    v_mfma_f32_16x16x32_bf16 v[18:21], v[14:17], v[44:47], v[18:21]
    v_mfma_f32_16x16x32_bf16 v[22:25], v[12:15], v[44:47], v[22:25]
    v_and_b32 v14, v31, v26
    v_and_b32 v15, v31, v27
    s_waitcnt vmcnt(25)
    v_mfma_f32_16x16x32_bf16 v[18:21], v[10:13], v[48:51], v[18:21]
    v_mfma_f32_16x16x32_bf16 v[22:25], v[8:11], v[48:51], v[22:25]
    v_and_b32 v10, v32, v26
    v_and_b32 v11, v32, v27
    s_waitcnt vmcnt(7)
    buffer_load_dwordx4 v[152:155], v6, s[8:11], s58 offen nt
    s_add_u32 s58, s58, 4096
    s_waitcnt vmcnt(25)
    v_mfma_f32_16x16x32_bf16 v[18:21], v[14:17], v[52:55], v[18:21]
    v_mfma_f32_16x16x32_bf16 v[22:25], v[12:15], v[52:55], v[22:25]
    v_and_b32 v14, v33, v26
    v_and_b32 v15, v33, v27
    s_waitcnt vmcnt(24)
    v_mfma_f32_16x16x32_bf16 v[18:21], v[10:13], v[56:59], v[18:21]
    v_mfma_f32_16x16x32_bf16 v[22:25], v[8:11], v[56:59], v[22:25]
    v_and_b32 v10, v34, v26
    v_and_b32 v11, v34, v27
    s_waitcnt vmcnt(23)
    v_mfma_f32_16x16x32_bf16 v[18:21], v[14:17], v[60:63], v[18:21]
    v_mfma_f32_16x16x32_bf16 v[22:25], v[12:15], v[60:63], v[22:25]
    v_and_b32 v14, v35, v26
    v_and_b32 v15, v35, v27
    s_waitcnt vmcnt(7)
    buffer_load_dwordx4 v[156:159], v6, s[8:11], s58 offen nt
    s_add_u32 s58, s58, 4096
    s_waitcnt vmcnt(23)
    v_mfma_f32_16x16x32_bf16 v[18:21], v[10:13], v[64:67], v[18:21]
    v_mfma_f32_16x16x32_bf16 v[22:25], v[8:11], v[64:67], v[22:25]
    ds_read_b128 v[40:43], v37 offset:2592
    ds_read_b128 v[44:47], v37 offset:2608
    ds_read_b128 v[48:51], v37 offset:2624
    ds_read_b128 v[52:55], v37 offset:2640
    ds_read_b128 v[56:59], v37 offset:2656
    ds_read_b128 v[60:63], v37 offset:2672
    s_waitcnt lgkmcnt(0)
    v_and_b32 v10, v40, v26
    v_and_b32 v11, v40, v27
    s_waitcnt vmcnt(22)
    v_mfma_f32_16x16x32_bf16 v[18:21], v[14:17], v[68:71], v[18:21]
    v_mfma_f32_16x16x32_bf16 v[22:25], v[12:15], v[68:71], v[22:25]
    v_and_b32 v14, v41, v26
    v_and_b32 v15, v41, v27
    s_waitcnt vmcnt(21)
    v_mfma_f32_16x16x32_bf16 v[18:21], v[10:13], v[72:75], v[18:21]
    v_mfma_f32_16x16x32_bf16 v[22:25], v[8:11], v[72:75], v[22:25]
    v_and_b32 v10, v42, v26
    v_and_b32 v11, v42, v27
    s_waitcnt vmcnt(7)
    buffer_load_dwordx4 v[160:163], v6, s[8:11], s58 offen nt
    s_add_u32 s58, s58, 4096
    s_waitcnt vmcnt(21)
    v_mfma_f32_16x16x32_bf16 v[18:21], v[14:17], v[76:79], v[18:21]
    v_mfma_f32_16x16x32_bf16 v[22:25], v[12:15], v[76:79], v[22:25]
    v_and_b32 v14, v43, v26
    v_and_b32 v15, v43, v27
    s_waitcnt vmcnt(20)
    v_mfma_f32_16x16x32_bf16 v[18:21], v[10:13], v[80:83], v[18:21]
    v_mfma_f32_16x16x32_bf16 v[22:25], v[8:11], v[80:83], v[22:25]
    v_lshlrev_b32 v28, 5, v0
    s_lshl_b32 s59, s60, 11
    v_add_u32 v28, s59, v28
    v_mov_b32 v29, 1
    s_lshl_b32 s61, s6, 20
    s_mul_i32 s59, s4, 90112
    s_add_u32 s61, s61, s59
    s_lshl_b32 s59, s60, 14
    s_add_u32 s61, s61, s59
    s_lshl_b32 s59, s5, 6
    s_add_u32 s61, s61, s59
    s_add_u32 s61, s61, 24576
    v_lshlrev_b32 v30, 4, v0
    s_lshl_b32 s59, s60, 9
    v_add_u32 v30, s59, v30
    v_lshrrev_b32 v31, 2, v0
    v_lshlrev_b32 v31, 11, v31
    v_lshl_add_u32 v31, v4, 4, v31
    v_and_b32 v10, v44, v26
    v_and_b32 v11, v44, v27
    s_waitcnt vmcnt(19)
    v_mfma_f32_16x16x32_bf16 v[18:21], v[14:17], v[84:87], v[18:21]
    v_mfma_f32_16x16x32_bf16 v[22:25], v[12:15], v[84:87], v[22:25]
    v_and_b32 v14, v45, v26
    v_and_b32 v15, v45, v27
    s_waitcnt vmcnt(7)
    buffer_load_dwordx4 v[164:167], v6, s[8:11], s58 offen nt
    s_add_u32 s58, s58, 4096
    v_mov_b32 v7, 1
    s_mov_b64 exec, 1
    ds_add_u32 v5, v7 offset:12
    s_mov_b64 exec, -1
    s_waitcnt vmcnt(19)
    v_mfma_f32_16x16x32_bf16 v[18:21], v[10:13], v[88:91], v[18:21]
    v_mfma_f32_16x16x32_bf16 v[22:25], v[8:11], v[88:91], v[22:25]
    v_and_b32 v10, v46, v26
    v_and_b32 v11, v46, v27
    s_waitcnt vmcnt(18)
    v_mfma_f32_16x16x32_bf16 v[18:21], v[14:17], v[92:95], v[18:21]
    v_mfma_f32_16x16x32_bf16 v[22:25], v[12:15], v[92:95], v[22:25]
    v_and_b32 v14, v47, v26
    v_and_b32 v15, v47, v27
    s_waitcnt vmcnt(17)
    v_mfma_f32_16x16x32_bf16 v[18:21], v[10:13], v[96:99], v[18:21]
    v_mfma_f32_16x16x32_bf16 v[22:25], v[8:11], v[96:99], v[22:25]
    v_and_b32 v10, v48, v26
    v_and_b32 v11, v48, v27
    s_waitcnt vmcnt(16)
    v_mfma_f32_16x16x32_bf16 v[18:21], v[14:17], v[100:103], v[18:21]
    v_mfma_f32_16x16x32_bf16 v[22:25], v[12:15], v[100:103], v[22:25]
    v_and_b32 v14, v49, v26
    v_and_b32 v15, v49, v27
    s_waitcnt vmcnt(15)
    v_mfma_f32_16x16x32_bf16 v[18:21], v[10:13], v[104:107], v[18:21]
    v_mfma_f32_16x16x32_bf16 v[22:25], v[8:11], v[104:107], v[22:25]
    v_and_b32 v10, v50, v26
    v_and_b32 v11, v50, v27
    s_waitcnt vmcnt(14)
    v_mfma_f32_16x16x32_bf16 v[18:21], v[14:17], v[108:111], v[18:21]
    v_mfma_f32_16x16x32_bf16 v[22:25], v[12:15], v[108:111], v[22:25]
    v_and_b32 v14, v51, v26
    v_and_b32 v15, v51, v27
    s_waitcnt vmcnt(13)
    v_mfma_f32_16x16x32_bf16 v[18:21], v[10:13], v[112:115], v[18:21]
    v_mfma_f32_16x16x32_bf16 v[22:25], v[8:11], v[112:115], v[22:25]
    v_and_b32 v10, v52, v26
    v_and_b32 v11, v52, v27
    s_waitcnt vmcnt(12)
    v_mfma_f32_16x16x32_bf16 v[18:21], v[14:17], v[116:119], v[18:21]
    v_mfma_f32_16x16x32_bf16 v[22:25], v[12:15], v[116:119], v[22:25]
    v_and_b32 v14, v53, v26
    v_and_b32 v15, v53, v27
    s_waitcnt vmcnt(11)
    v_mfma_f32_16x16x32_bf16 v[18:21], v[10:13], v[120:123], v[18:21]
    v_mfma_f32_16x16x32_bf16 v[22:25], v[8:11], v[120:123], v[22:25]
    v_and_b32 v10, v54, v26
    v_and_b32 v11, v54, v27
    s_waitcnt vmcnt(10)
    v_mfma_f32_16x16x32_bf16 v[18:21], v[14:17], v[124:127], v[18:21]
    v_mfma_f32_16x16x32_bf16 v[22:25], v[12:15], v[124:127], v[22:25]
    v_and_b32 v14, v55, v26
    v_and_b32 v15, v55, v27
    s_waitcnt vmcnt(9)
    v_mfma_f32_16x16x32_bf16 v[18:21], v[10:13], v[128:131], v[18:21]
    v_mfma_f32_16x16x32_bf16 v[22:25], v[8:11], v[128:131], v[22:25]
    v_and_b32 v10, v56, v26
    v_and_b32 v11, v56, v27
    s_waitcnt vmcnt(8)
    v_mfma_f32_16x16x32_bf16 v[18:21], v[14:17], v[132:135], v[18:21]
    v_mfma_f32_16x16x32_bf16 v[22:25], v[12:15], v[132:135], v[22:25]
    v_and_b32 v14, v57, v26
    v_and_b32 v15, v57, v27
    s_waitcnt vmcnt(7)
    v_mfma_f32_16x16x32_bf16 v[18:21], v[10:13], v[136:139], v[18:21]
    v_mfma_f32_16x16x32_bf16 v[22:25], v[8:11], v[136:139], v[22:25]
    v_and_b32 v10, v58, v26
    v_and_b32 v11, v58, v27
    s_waitcnt vmcnt(6)
    v_mfma_f32_16x16x32_bf16 v[18:21], v[14:17], v[140:143], v[18:21]
    v_mfma_f32_16x16x32_bf16 v[22:25], v[12:15], v[140:143], v[22:25]
    v_and_b32 v14, v59, v26
    v_and_b32 v15, v59, v27
    s_waitcnt vmcnt(5)
    v_mfma_f32_16x16x32_bf16 v[18:21], v[10:13], v[144:147], v[18:21]
    v_mfma_f32_16x16x32_bf16 v[22:25], v[8:11], v[144:147], v[22:25]
    v_and_b32 v10, v60, v26
    v_and_b32 v11, v60, v27
    s_waitcnt vmcnt(4)
    v_mfma_f32_16x16x32_bf16 v[18:21], v[14:17], v[148:151], v[18:21]
    v_mfma_f32_16x16x32_bf16 v[22:25], v[12:15], v[148:151], v[22:25]
    v_and_b32 v14, v61, v26
    v_and_b32 v15, v61, v27
    s_waitcnt vmcnt(3)
    v_mfma_f32_16x16x32_bf16 v[18:21], v[10:13], v[152:155], v[18:21]
    v_mfma_f32_16x16x32_bf16 v[22:25], v[8:11], v[152:155], v[22:25]
    v_and_b32 v10, v62, v26
    v_and_b32 v11, v62, v27
    s_waitcnt vmcnt(2)
    v_mfma_f32_16x16x32_bf16 v[18:21], v[14:17], v[156:159], v[18:21]
    v_mfma_f32_16x16x32_bf16 v[22:25], v[12:15], v[156:159], v[22:25]
    v_and_b32 v14, v63, v26
    v_and_b32 v15, v63, v27
    s_waitcnt vmcnt(1)
    v_mfma_f32_16x16x32_bf16 v[18:21], v[10:13], v[160:163], v[18:21]
    v_mfma_f32_16x16x32_bf16 v[22:25], v[8:11], v[160:163], v[22:25]
    s_nop 1
    s_waitcnt vmcnt(0)
    v_mfma_f32_16x16x32_bf16 v[18:21], v[14:17], v[164:167], v[18:21]
    v_mfma_f32_16x16x32_bf16 v[22:25], v[12:15], v[164:167], v[22:25]
    s_branch L_pv_done
L_vp_28:
    ds_read_b32 v39, v5 offset:0
    ds_read_b128 v[28:31], v37 offset:2560
    ds_read_b128 v[32:35], v37 offset:2576
    s_waitcnt vmcnt(7)
    buffer_load_dwordx4 v[152:155], v6, s[8:11], s58 offen nt
    s_add_u32 s58, s58, 4096
    s_waitcnt vmcnt(7)
    buffer_load_dwordx4 v[156:159], v6, s[8:11], s58 offen nt
    s_add_u32 s58, s58, 4096
    s_waitcnt vmcnt(7)
    buffer_load_dwordx4 v[160:163], v6, s[8:11], s58 offen nt
    s_add_u32 s58, s58, 4096
    s_waitcnt vmcnt(7)
    buffer_load_dwordx4 v[164:167], v6, s[8:11], s58 offen nt
    s_add_u32 s58, s58, 4096
    v_mov_b32 v7, 1
    s_mov_b64 exec, 1
    ds_add_u32 v5, v7 offset:12
    s_mov_b64 exec, -1
    s_waitcnt lgkmcnt(0)
    v_readfirstlane_b32 s6, v39
    v_and_b32 v10, v28, v26
    v_and_b32 v11, v28, v27
    v_and_b32 v14, v29, v26
    v_and_b32 v15, v29, v27
    s_waitcnt vmcnt(31)
    v_mfma_f32_16x16x32_bf16 v[18:21], v[10:13], v[40:43], v[18:21]
    v_mfma_f32_16x16x32_bf16 v[22:25], v[8:11], v[40:43], v[22:25]
    v_and_b32 v10, v30, v26
    v_and_b32 v11, v30, v27
    s_waitcnt vmcnt(30)
    v_mfma_f32_16x16x32_bf16 v[18:21], v[14:17], v[44:47], v[18:21]
    v_mfma_f32_16x16x32_bf16 v[22:25], v[12:15], v[44:47], v[22:25]
    v_and_b32 v14, v31, v26
    v_and_b32 v15, v31, v27
    s_waitcnt vmcnt(29)
    v_mfma_f32_16x16x32_bf16 v[18:21], v[10:13], v[48:51], v[18:21]
    v_mfma_f32_16x16x32_bf16 v[22:25], v[8:11], v[48:51], v[22:25]
    v_and_b32 v10, v32, v26
    v_and_b32 v11, v32, v27
    s_waitcnt vmcnt(28)
    v_mfma_f32_16x16x32_bf16 v[18:21], v[14:17], v[52:55], v[18:21]
    v_mfma_f32_16x16x32_bf16 v[22:25], v[12:15], v[52:55], v[22:25]
    v_and_b32 v14, v33, v26
    v_and_b32 v15, v33, v27
    s_waitcnt vmcnt(27)
    v_mfma_f32_16x16x32_bf16 v[18:21], v[10:13], v[56:59], v[18:21]
    v_mfma_f32_16x16x32_bf16 v[22:25], v[8:11], v[56:59], v[22:25]
    v_and_b32 v10, v34, v26
    v_and_b32 v11, v34, v27
    s_waitcnt vmcnt(26)
    v_mfma_f32_16x16x32_bf16 v[18:21], v[14:17], v[60:63], v[18:21]
    v_mfma_f32_16x16x32_bf16 v[22:25], v[12:15], v[60:63], v[22:25]
    v_and_b32 v14, v35, v26
    v_and_b32 v15, v35, v27
    s_waitcnt vmcnt(25)
    v_mfma_f32_16x16x32_bf16 v[18:21], v[10:13], v[64:67], v[18:21]
    v_mfma_f32_16x16x32_bf16 v[22:25], v[8:11], v[64:67], v[22:25]
    ds_read_b128 v[40:43], v37 offset:2592
    ds_read_b128 v[44:47], v37 offset:2608
    ds_read_b128 v[48:51], v37 offset:2624
    ds_read_b128 v[52:55], v37 offset:2640
    ds_read_b128 v[56:59], v37 offset:2656
    ds_read_b128 v[60:63], v37 offset:2672
    s_waitcnt lgkmcnt(0)
    v_and_b32 v10, v40, v26
    v_and_b32 v11, v40, v27
    s_waitcnt vmcnt(24)
    v_mfma_f32_16x16x32_bf16 v[18:21], v[14:17], v[68:71], v[18:21]
    v_mfma_f32_16x16x32_bf16 v[22:25], v[12:15], v[68:71], v[22:25]
    v_and_b32 v14, v41, v26
    v_and_b32 v15, v41, v27
    s_waitcnt vmcnt(23)
    v_mfma_f32_16x16x32_bf16 v[18:21], v[10:13], v[72:75], v[18:21]
    v_mfma_f32_16x16x32_bf16 v[22:25], v[8:11], v[72:75], v[22:25]
    v_and_b32 v10, v42, v26
    v_and_b32 v11, v42, v27
    s_waitcnt vmcnt(22)
    v_mfma_f32_16x16x32_bf16 v[18:21], v[14:17], v[76:79], v[18:21]
    v_mfma_f32_16x16x32_bf16 v[22:25], v[12:15], v[76:79], v[22:25]
    v_and_b32 v14, v43, v26
    v_and_b32 v15, v43, v27
    s_waitcnt vmcnt(21)
    v_mfma_f32_16x16x32_bf16 v[18:21], v[10:13], v[80:83], v[18:21]
    v_mfma_f32_16x16x32_bf16 v[22:25], v[8:11], v[80:83], v[22:25]
    v_lshlrev_b32 v28, 5, v0
    s_lshl_b32 s59, s60, 11
    v_add_u32 v28, s59, v28
    v_mov_b32 v29, 1
    s_lshl_b32 s61, s6, 20
    s_mul_i32 s59, s4, 90112
    s_add_u32 s61, s61, s59
    s_lshl_b32 s59, s60, 14
    s_add_u32 s61, s61, s59
    s_lshl_b32 s59, s5, 6
    s_add_u32 s61, s61, s59
    s_add_u32 s61, s61, 24576
    v_lshlrev_b32 v30, 4, v0
    s_lshl_b32 s59, s60, 9
    v_add_u32 v30, s59, v30
    v_lshrrev_b32 v31, 2, v0
    v_lshlrev_b32 v31, 11, v31
    v_lshl_add_u32 v31, v4, 4, v31
    v_and_b32 v10, v44, v26
    v_and_b32 v11, v44, v27
    s_waitcnt vmcnt(20)
    v_mfma_f32_16x16x32_bf16 v[18:21], v[14:17], v[84:87], v[18:21]
    v_mfma_f32_16x16x32_bf16 v[22:25], v[12:15], v[84:87], v[22:25]
    v_and_b32 v14, v45, v26
    v_and_b32 v15, v45, v27
    s_waitcnt vmcnt(19)
    v_mfma_f32_16x16x32_bf16 v[18:21], v[10:13], v[88:91], v[18:21]
    v_mfma_f32_16x16x32_bf16 v[22:25], v[8:11], v[88:91], v[22:25]
    v_and_b32 v10, v46, v26
    v_and_b32 v11, v46, v27
    s_waitcnt vmcnt(18)
    v_mfma_f32_16x16x32_bf16 v[18:21], v[14:17], v[92:95], v[18:21]
    v_mfma_f32_16x16x32_bf16 v[22:25], v[12:15], v[92:95], v[22:25]
    v_and_b32 v14, v47, v26
    v_and_b32 v15, v47, v27
    s_waitcnt vmcnt(17)
    v_mfma_f32_16x16x32_bf16 v[18:21], v[10:13], v[96:99], v[18:21]
    v_mfma_f32_16x16x32_bf16 v[22:25], v[8:11], v[96:99], v[22:25]
    v_and_b32 v10, v48, v26
    v_and_b32 v11, v48, v27
    s_waitcnt vmcnt(16)
    v_mfma_f32_16x16x32_bf16 v[18:21], v[14:17], v[100:103], v[18:21]
    v_mfma_f32_16x16x32_bf16 v[22:25], v[12:15], v[100:103], v[22:25]
    v_and_b32 v14, v49, v26
    v_and_b32 v15, v49, v27
    s_waitcnt vmcnt(15)
    v_mfma_f32_16x16x32_bf16 v[18:21], v[10:13], v[104:107], v[18:21]
    v_mfma_f32_16x16x32_bf16 v[22:25], v[8:11], v[104:107], v[22:25]
    v_and_b32 v10, v50, v26
    v_and_b32 v11, v50, v27
    s_waitcnt vmcnt(14)
    v_mfma_f32_16x16x32_bf16 v[18:21], v[14:17], v[108:111], v[18:21]
    v_mfma_f32_16x16x32_bf16 v[22:25], v[12:15], v[108:111], v[22:25]
    v_and_b32 v14, v51, v26
    v_and_b32 v15, v51, v27
    s_waitcnt vmcnt(13)
    v_mfma_f32_16x16x32_bf16 v[18:21], v[10:13], v[112:115], v[18:21]
    v_mfma_f32_16x16x32_bf16 v[22:25], v[8:11], v[112:115], v[22:25]
    v_and_b32 v10, v52, v26
    v_and_b32 v11, v52, v27
    s_waitcnt vmcnt(12)
    v_mfma_f32_16x16x32_bf16 v[18:21], v[14:17], v[116:119], v[18:21]
    v_mfma_f32_16x16x32_bf16 v[22:25], v[12:15], v[116:119], v[22:25]
    v_and_b32 v14, v53, v26
    v_and_b32 v15, v53, v27
    s_waitcnt vmcnt(11)
    v_mfma_f32_16x16x32_bf16 v[18:21], v[10:13], v[120:123], v[18:21]
    v_mfma_f32_16x16x32_bf16 v[22:25], v[8:11], v[120:123], v[22:25]
    v_and_b32 v10, v54, v26
    v_and_b32 v11, v54, v27
    s_waitcnt vmcnt(10)
    v_mfma_f32_16x16x32_bf16 v[18:21], v[14:17], v[124:127], v[18:21]
    v_mfma_f32_16x16x32_bf16 v[22:25], v[12:15], v[124:127], v[22:25]
    v_and_b32 v14, v55, v26
    v_and_b32 v15, v55, v27
    s_waitcnt vmcnt(9)
    v_mfma_f32_16x16x32_bf16 v[18:21], v[10:13], v[128:131], v[18:21]
    v_mfma_f32_16x16x32_bf16 v[22:25], v[8:11], v[128:131], v[22:25]
    v_and_b32 v10, v56, v26
    v_and_b32 v11, v56, v27
    s_waitcnt vmcnt(8)
    v_mfma_f32_16x16x32_bf16 v[18:21], v[14:17], v[132:135], v[18:21]
    v_mfma_f32_16x16x32_bf16 v[22:25], v[12:15], v[132:135], v[22:25]
    v_and_b32 v14, v57, v26
    v_and_b32 v15, v57, v27
    s_waitcnt vmcnt(7)
    v_mfma_f32_16x16x32_bf16 v[18:21], v[10:13], v[136:139], v[18:21]
    v_mfma_f32_16x16x32_bf16 v[22:25], v[8:11], v[136:139], v[22:25]
    v_and_b32 v10, v58, v26
    v_and_b32 v11, v58, v27
    s_waitcnt vmcnt(6)
    v_mfma_f32_16x16x32_bf16 v[18:21], v[14:17], v[140:143], v[18:21]
    v_mfma_f32_16x16x32_bf16 v[22:25], v[12:15], v[140:143], v[22:25]
    v_and_b32 v14, v59, v26
    v_and_b32 v15, v59, v27
    s_waitcnt vmcnt(5)
    v_mfma_f32_16x16x32_bf16 v[18:21], v[10:13], v[144:147], v[18:21]
    v_mfma_f32_16x16x32_bf16 v[22:25], v[8:11], v[144:147], v[22:25]
    v_and_b32 v10, v60, v26
    v_and_b32 v11, v60, v27
    s_waitcnt vmcnt(4)
    v_mfma_f32_16x16x32_bf16 v[18:21], v[14:17], v[148:151], v[18:21]
    v_mfma_f32_16x16x32_bf16 v[22:25], v[12:15], v[148:151], v[22:25]
    v_and_b32 v14, v61, v26
    v_and_b32 v15, v61, v27
    s_waitcnt vmcnt(3)
    v_mfma_f32_16x16x32_bf16 v[18:21], v[10:13], v[152:155], v[18:21]
    v_mfma_f32_16x16x32_bf16 v[22:25], v[8:11], v[152:155], v[22:25]
    v_and_b32 v10, v62, v26
    v_and_b32 v11, v62, v27
    s_waitcnt vmcnt(2)
    v_mfma_f32_16x16x32_bf16 v[18:21], v[14:17], v[156:159], v[18:21]
    v_mfma_f32_16x16x32_bf16 v[22:25], v[12:15], v[156:159], v[22:25]
    v_and_b32 v14, v63, v26
    v_and_b32 v15, v63, v27
    s_waitcnt vmcnt(1)
    v_mfma_f32_16x16x32_bf16 v[18:21], v[10:13], v[160:163], v[18:21]
    v_mfma_f32_16x16x32_bf16 v[22:25], v[8:11], v[160:163], v[22:25]
    s_nop 1
    s_waitcnt vmcnt(0)
    v_mfma_f32_16x16x32_bf16 v[18:21], v[14:17], v[164:167], v[18:21]
    v_mfma_f32_16x16x32_bf16 v[22:25], v[12:15], v[164:167], v[22:25]
L_pv_done:
    s_nop 6
    ds_write_b128 v28, v[18:21] offset:11776
    ds_write_b128 v28, v[22:25] offset:11792
    s_mov_b64 exec, 1
    ds_add_u32 v5, v29 offset:32
    s_mov_b64 exec, -1
    s_mov_b32 s54, 0
L_lw_39:
    ds_read_b32 v7, v5 offset:32
    s_add_u32 s54, s54, 1
    s_waitcnt lgkmcnt(0)
    v_readfirstlane_b32 s53, v7
    s_cmp_gt_u32 s54, 1048576
    s_cbranch_scc1 L_lwd_40
    s_cmp_ge_u32 s53, 4
    s_cbranch_scc1 L_lwd_40
    s_branch L_lw_39
L_lwd_40:
    s_mov_b64 exec, 0xffffffff
    ds_read_b128 v[40:43], v30 offset:11776
    ds_read_b128 v[44:47], v30 offset:13824
    ds_read_b128 v[48:51], v30 offset:15872
    ds_read_b128 v[52:55], v30 offset:17920
    s_waitcnt lgkmcnt(2)
    v_add_f32 v40, v40, v44
    v_add_f32 v41, v41, v45
    v_add_f32 v42, v42, v46
    v_add_f32 v43, v43, v47
    s_waitcnt lgkmcnt(0)
    v_add_f32 v48, v48, v52
    v_add_f32 v49, v49, v53
    v_add_f32 v50, v50, v54
    v_add_f32 v51, v51, v55
    v_add_f32 v40, v40, v48
    v_add_f32 v41, v41, v49
    v_add_f32 v42, v42, v50
    v_add_f32 v43, v43, v51
    s_cmp_eq_u32 s6, 1
    s_cbranch_scc0 L_slow_41
    buffer_store_dwordx4 v[40:43], v31, s[12:15], s61 offen
L_back_42:
    s_mov_b64 exec, -1
    v_mov_b32 v7, 1
    s_mov_b64 exec, 1
    ds_add_u32 v5, v7 offset:32
    s_mov_b64 exec, -1
    s_endpgm
L_slow_3:
    buffer_store_dwordx2 v[42:43], v27, s[12:15], s59 offen sc1
    s_branch L_back_4
L_slow_15:
    buffer_store_short v8, v21, s[12:15], s61 offen offset:0 sc1
    s_branch L_back_16
L_slow_21:
    buffer_store_short v8, v22, s[12:15], s61 offen offset:1024 sc1
    s_branch L_back_22
L_slow_41:
    buffer_store_dwordx4 v[40:43], v31, s[12:15], s61 offen sc1
    s_branch L_back_42
L_slow_53:
    buffer_store_dwordx4 v[8:11], v112, s[12:15], s59 offen sc1
    s_branch L_back_54
L_slow_81:
    buffer_store_dwordx4 v[8:11], v112, s[12:15], s47 offen sc1
    s_branch L_back_82
.fill 4096, 4, 0xBF800000
.section .rodata,"a"
.p2align 6
.amdhsa_kernel adaLN_cond__gqa_block_cached__geglu_ffn__decode_kernel
  .amdhsa_next_free_vgpr 168
  .amdhsa_next_free_sgpr 102
  .amdhsa_accum_offset 168
  .amdhsa_group_segment_fixed_size 0
  .amdhsa_kernarg_size 112
  .amdhsa_user_sgpr_count 2
  .amdhsa_user_sgpr_kernarg_segment_ptr 1
  .amdhsa_system_sgpr_workgroup_id_x 1
  .amdhsa_float_denorm_mode_32 3
  .amdhsa_float_denorm_mode_16_64 3
.end_amdhsa_kernel
```
